```python
import torch

def _softmax(x, axis=-1):
    return torch.softmax(x, dim=axis)
def _gelu(x):
    return torch.nn.functional.gelu(x, approximate="tanh")
def _silu(x):
    return torch.nn.functional.silu(x)
def _sigmoid(x):
    return torch.sigmoid(x)
def _layernorm(x, axis=-1, eps=1e-5):
    m = x.mean(dim=axis, keepdim=True)
    v = x.var(dim=axis, keepdim=True, unbiased=False)
    return (x - m) / torch.sqrt(v + eps)
def _scatter_add(tgt, idx, src, axis=0):
    return tgt.clone().index_add_(axis, idx, src)
def _segment_sum(src, seg, n):
    out = torch.zeros((n,) + src.shape[1:], dtype=src.dtype)
    return out.index_add_(0, seg, src)
def _pad(x, pw):
    flat = tuple(v for pair in reversed(pw) for v in pair)
    return torch.nn.functional.pad(x, flat)

kernel_name = 'recurrent_scan__spectral_fnet__moe_arch_mod__prompt'

def setup_inputs():

    _w = (lambda a: (lambda t: t.to(torch.bfloat16) if t.is_floating_point() else t)(torch.as_tensor(a)))
    def _A_setup():
        B, S, D = 1, 2048, 448
        ns = torch.arange(S)[:, None] * torch.arange(S)[None, :]
        nd = torch.arange(D)[:, None] * torch.arange(D)[None, :]
        Ws_re = torch.cos(-2.0 * torch.pi * ns / S).to(float)
        Ws_im = torch.sin(-2.0 * torch.pi * ns / S).to(float)
        Wd_re = torch.cos(-2.0 * torch.pi * nd / D).to(float)
        Wd_im = torch.sin(-2.0 * torch.pi * nd / D).to(float)
        return {
            "x": _w((lambda *s: torch.randn(*s, dtype=torch.bfloat16) * 0.05)(B, S, D)),
            "dft_seq_re": _w(Ws_re),
            "dft_seq_im": _w(Ws_im),
            "dft_hid_re": _w(Wd_re),
            "dft_hid_im": _w(Wd_im),
        }
    _A_in = _A_setup()

    def _B_setup():
        B, S, D, F, C = 1, 2048, 448, 1792, 1
        return {
            "x": _w((lambda *s: torch.randn(*s, dtype=torch.bfloat16) * 0.05)(B, S, D)),
            "w_r": _w((lambda *s: torch.randn(*s, dtype=torch.bfloat16) * 0.05)(D)),
            "w_gate": _w((lambda *s: torch.randn(*s, dtype=torch.bfloat16) * 0.05)(D, F)),
            "w_up": _w((lambda *s: torch.randn(*s, dtype=torch.bfloat16) * 0.05)(D, F)),
            "w_down": _w((lambda *s: torch.randn(*s, dtype=torch.bfloat16) * 0.05)(F, D)),
        }
    _B_in = _B_setup()

    return {
        "A_x": _A_in["x"],
        "A_dft_seq_re": _A_in["dft_seq_re"],
        "A_dft_seq_im": _A_in["dft_seq_im"],
        "A_dft_hid_re": _A_in["dft_hid_re"],
        "A_dft_hid_im": _A_in["dft_hid_im"],
        "B_x": _B_in["x"],
        "B_w_r": _B_in["w_r"],
        "B_w_gate": _B_in["w_gate"],
        "B_w_up": _B_in["w_up"],
        "B_w_down": _B_in["w_down"],
    }

def reference(A_x, A_dft_seq_re, A_dft_seq_im, A_dft_hid_re, A_dft_hid_im, B_x, B_w_r, B_w_gate, B_w_up, B_w_down):
    def _A_ref(x, dft_seq_re, dft_seq_im, dft_hid_re, dft_hid_im):
        a = torch.einsum("bsd,ed->bse", x, dft_hid_re)
        b = torch.einsum("bsd,ed->bse", x, dft_hid_im)
        y = torch.einsum("ts,bse->bte", dft_seq_re, a) - torch.einsum("ts,bse->bte", dft_seq_im, b)
        return y

    def _B_ref(x, w_r, w_gate, w_up, w_down):
        B, S, D = x.shape
        C = 1
        r = x @ w_r
        idx = torch.argsort(-r, axis=-1)[:, :C]
        idx_e = (lambda x, n, axis: torch.repeat_interleave(x, n, dim=axis))(idx.reshape(B, C, 1), D, axis=2)
        x_sel = (lambda x, i, axis: torch.take_along_dim(x, i, dim=axis))(x, idx_e, axis=1)
        g = _silu(x_sel @ w_gate)
        u = x_sel @ w_up
        y = (g * u) @ w_down
        r_sel = _sigmoid((lambda x, i, axis: torch.take_along_dim(x, i, dim=axis))(r, idx, axis=1))
        y = y * r_sel.reshape(B, C, 1)
        b_off = (torch.arange(B) * S).reshape(B, 1)
        flat_idx = (idx + b_off).reshape(B * C)
        zero = (x * 0.0).reshape(B * S, D)
        upd = _scatter_add(zero, flat_idx, y.reshape(B * C, D), axis=0)
        return x + upd.reshape(B, S, D)

    x = A_x
    xn = _layernorm(x, axis=-1)
    s = _A_ref(xn, A_dft_seq_re, A_dft_seq_im, A_dft_hid_re, A_dft_hid_im)
    g = _silu(_B_ref(xn, B_w_r, B_w_gate, B_w_up, B_w_down))
    return x + s * g
```

```asm
; @launch grid=(256,1,1) block=(512,1,1) lds=128000
.amdgcn_target "amdgcn-amd-amdhsa--gfx950"
.text
.globl recurrent_scan__spectral_fnet__moe_arch_mod__prompt_kernel
.p2align 8
.type recurrent_scan__spectral_fnet__moe_arch_mod__prompt_kernel,@function
recurrent_scan__spectral_fnet__moe_arch_mod__prompt_kernel:
s_load_dwordx2 s[4:5], s[0:1], 0
s_load_dwordx8 s[8:15], s[0:1], 48
s_load_dwordx2 s[16:17], s[0:1], 80
s_load_dwordx2 s[20:21], s[0:1], 96
v_lshrrev_b32 v1, 6, v0
s_mov_b32 s6, 1835008
s_mov_b32 s7, 0x20000
v_readfirstlane_b32 s24, v1
v_and_b32 v0, 63, v0
s_cmp_lg_u32 s24, 0
s_cbranch_scc1 L_nocp
s_getpc_b64 s[26:27]
s_bfe_u32 s25, s2, 0x40003
s_mul_i32 s25, s25, 768
v_min_u32 v2, 5, v0
v_lshl_add_u32 v2, v2, 7, s25
v_mov_b32 v3, 0
v_lshl_add_u64 v[2:3], v[2:3], 0, s[26:27]
global_load_dword v255, v[2:3], off offset:384
L_nocp:
s_mov_b32 s22, 4194304
s_mov_b32 s23, s7
s_mov_b32 s18, s6
s_mov_b32 s19, s7
s_and_b32 s25, s2, 7
s_cmp_ge_u32 s2, 128
s_cbranch_scc1 L_other
s_lshr_b32 s28, s2, 6
s_sub_u32 s26, 16, s25
s_cmp_eq_u32 s25, 0
s_cselect_b32 s26, 8, s26
s_bitcmp1_b32 s2, 3
s_cselect_b32 s26, s26, s25
s_and_b32 s27, s2, 48
s_add_u32 s26, s27, s26
s_sub_u32 s27, 128, s26
s_cmp_eq_u32 s26, 0
s_cselect_b32 s27, 64, s27
s_cmp_lt_u32 s24, 4
s_cbranch_scc1 L_mfma
s_setprio 3
s_sub_u32 s29, s24, 4
s_bitcmp1_b32 s24, 1
s_cselect_b32 s32, s27, s26
s_and_b32 s33, s24, 1
s_lshl_b32 s34, s33, 10
s_add_u32 s32, s32, s34
v_lshrrev_b32 v1, 3, v0
v_lshl_add_u32 v2, v1, 7, s32
v_mul_u32_u24 v3, 896, v2
v_lshrrev_b32 v4, 4, v0
v_lshlrev_b32 v5, 2, v4
v_xor_b32 v5, v0, v5
v_and_b32 v5, 7, v5
v_lshl_add_u32 v3, v5, 4, v3
v_lshlrev_b32 v6, 4, v0
s_mul_i32 s35, s29, 7168
s_mul_i32 s36, s28, 384
s_mov_b32 s37, 7
v_min_u32 v7, 0x370, v6
s_cmp_lg_u32 s28, 0
s_waitcnt lgkmcnt(0)
s_load_dwordx2 s[30:31], s[20:21], 0
s_cbranch_scc1 L_xl
global_load_dwordx4 v[52:55], v7, s[8:9]
L_xl:
s_lshl3_add_u32 m0, s36, s35
s_sub_u32 s37, s37, 1
buffer_load_dwordx4 v3, s[4:7], s36 offen  lds
s_add_u32 s36, s36, 128
s_cmp_eq_u32 s36, 896
s_cselect_b32 s36, 0, s36
s_cmp_lg_u32 s37, 0
s_cbranch_scc1 L_xl
v_and_b32 v10, 15, v0
v_lshrrev_b32 v11, 2, v10
v_and_b32_e64 v12, 1, v0
v_lshl_add_u32 v13, v11, 1, v12
v_cmp_eq_u32 s[54:55], 1, v12
s_lshl_b32 s46, s29, 5
v_lshl_add_u32 v16, v13, 2, s46
v_lshl_add_u32 v2, v13, 7, s32
v_and_or_b32 v11, v0, 4, v4
v_lshl_add_u32 v11, v13, 3, v11
v_lshl_add_u32 v48, v11, 4, s35
v_and_b32 v11, 2, v0
v_cmp_eq_u32 vcc, 2, v11
s_lshl_b32 s38, s29, 8
s_add_u32 s38, s38, 37376
v_lshl_add_u32 v13, v12, 3, v4
v_lshl_add_u32 v13, v13, 4, s38
v_cndmask_b32 v48, v48, v13, vcc
s_mul_i32 s44, s28, 3072
s_xor_b32 s45, s28, 1
s_mul_i32 s45, s45, 4096
v_add_u32 v50, s45, v48
v_add_u32 v48, s44, v48
v_xor_b32 v49, 64, v48
v_xor_b32 v51, 64, v50
v_and_b32 v8, 0x70, v6
v_lshl_add_u32 v7, v1, 10, v8
v_add_u32 v7, s38, v7
v_mov_b32 v56, 0x3f803f80
v_mov_b32 v57, v56
v_mov_b32 v58, v56
v_mov_b32 v59, v56
ds_write_b128 v7, v[56:59]
s_add_u32 s46, s46, 28672
v_lshl_add_u32 v17, v4, 2, s46
v_lshl_add_u32 v9, v1, 13, v8
s_lshl_b32 s50, s26, 7
s_add_u32 s50, s50, 65536
s_lshr_b32 s44, s29, 1
s_lshl_b32 s44, s44, 10
s_lshl3_add_u32 s44, s33, s44
s_add_u32 s44, s44, 95232
v_lshrrev_b32 v63, 2, v16
v_and_or_b32 v11, v63, 4, s44
v_and_b32 v63, 3, v63
v_lshl_add_u32 v63, v63, 8, v11
v_mov_b32 v19, 1
v_mov_b32 v60, 0
v_mov_b32 v61, 0
v_mov_b32 v62, 0
ds_write_b96 v60, v[60:62] offset:28928
v_lshl_add_u32 v13, v4, 7, s32
v_mul_u32_u24 v13, v13, v10
v_cvt_f32_u32 v13, v13
v_cvt_f32_u32 v14, v10
v_mul_f32 v13, 0x3a000000, v13
v_fmamk_f32 v14, v14, 0x3e800000, v13
s_mov_b32 s46, 0x3e800000
s_bitcmp1_b32 s24, 1
s_cselect_b32 s46, 0xbe800000, s46
s_cselect_b32 s56, 0, -1
s_cselect_b32 s57, -1, 0
s_cmp_eq_u32 s26, 0
s_cselect_b32 s46, 0, s46
s_cselect_b32 s56, s56, -1
s_cselect_b32 s57, s57, -1
v_add_f32 v15, s46, v13
v_add_f32 v46, s46, v14
v_cos_f32 v24, v13
v_sin_f32 v25, v13
v_cos_f32 v26, v14
v_sin_f32 v27, v14
v_cos_f32 v28, v15
v_sin_f32 v29, v15
v_cos_f32 v30, v46
v_sin_f32 v31, v46
s_lshr_b32 s46, s29, 1
s_lshl_b32 s46, s46, 10
s_lshl3_add_u32 s46, s33, s46
v_add_u32 v18, s46, v6
s_lshr_b32 s39, s2, 3
s_lshl4_add_u32 s39, s29, s39
s_add_u32 s39, s39, 36
s_cmp_lt_u32 s29, 2
s_cselect_b32 s39, s39, 999
s_cmp_ge_u32 s39, 49
s_cbranch_scc1 L_pdp
s_add_u32 s39, s39, 7
s_mul_i32 s42, s39, 9363
s_lshr_b32 s42, s42, 16
s_mul_i32 s44, s42, 7
s_sub_u32 s39, s39, s44
s_lshr_b32 s43, s42, 1
s_lshl2_add_u32 s39, s39, s43
s_mul_i32 s39, s39, 16*3584
s_mul_i32 s43, s25, 448
s_andn2_b32 s43, s43, 127
s_add_u32 s43, s43, s39
v_lshrrev_b32 v11, 2, v0
v_mul_u32_u24 v11, 28, v11
v_and_or_b32 v11, v0, 3, v11
s_bitcmp1_b32 s42, 0
s_cselect_b32 s40, s12, s10
s_cselect_b32 s41, s13, s11
s_branch L_pep
L_pdp:
s_sub_u32 s39, s39, 49
s_cmp_lt_u32 s39, 32
s_cselect_b32 s42, 48, 0
s_cselect_b32 s39, s39, 0
s_lshl_b32 s43, s25, 5
s_add_u32 s43, s43, s39
s_mul_i32 s43, s43, 49*128
v_min_u32 v11, s42, v0
s_mov_b32 s40, s14
s_mov_b32 s41, s15
L_pep:
v_lshl_add_u32 v11, v11, 7, s43
global_load_dword v255, v11, s[40:41]
s_waitcnt lgkmcnt(0)
s_add_u32 s30, s30, 2654435769
s_add_u32 s31, s31, 2135587861
v_mov_b32 v38, s30
v_mov_b32 v39, s31
s_mov_b32 s47, 0x7ff
s_brev_b32 s48, 1
s_call_b64 s[92:93], L_addr
s_cmp_lg_u32 s28, 0
s_cbranch_scc1 L_wsk
s_waitcnt vmcnt(8)
ds_write_b128 v7, v[52:55] offset:128
L_wsk:
s_waitcnt vmcnt(7)
ds_read_b128 v[64:67], v48 offset:0
ds_read_b128 v[68:71], v49 offset:0
s_waitcnt vmcnt(6)
ds_read_b128 v[72:75], v48 offset:1024
ds_read_b128 v[76:79], v49 offset:1024
s_waitcnt lgkmcnt(2)
v_mfma_f32_16x16x32_bf16 v[20:23], v[64:67], v[64:67], 0
v_mfma_f32_16x16x32_bf16 v[20:23], v[68:71], v[68:71], v[20:23]
s_waitcnt vmcnt(5)
ds_read_b128 v[80:83], v48 offset:2048
ds_read_b128 v[84:87], v49 offset:2048
s_waitcnt lgkmcnt(2)
v_mfma_f32_16x16x32_bf16 v[20:23], v[72:75], v[72:75], v[20:23]
v_mfma_f32_16x16x32_bf16 v[20:23], v[76:79], v[76:79], v[20:23]
s_waitcnt vmcnt(4)
ds_read_b128 v[88:91], v48 offset:3072
ds_read_b128 v[92:95], v49 offset:3072
s_waitcnt lgkmcnt(2)
v_mfma_f32_16x16x32_bf16 v[20:23], v[80:83], v[80:83], v[20:23]
v_mfma_f32_16x16x32_bf16 v[20:23], v[84:87], v[84:87], v[20:23]
s_waitcnt vmcnt(3)
ds_read_b128 v[96:99], v50 offset:0
ds_read_b128 v[100:103], v51 offset:0
s_waitcnt lgkmcnt(2)
v_mfma_f32_16x16x32_bf16 v[20:23], v[88:91], v[88:91], v[20:23]
v_mfma_f32_16x16x32_bf16 v[20:23], v[92:95], v[92:95], v[20:23]
s_waitcnt vmcnt(2)
ds_read_b128 v[104:107], v50 offset:1024
ds_read_b128 v[108:111], v51 offset:1024
s_waitcnt lgkmcnt(2)
v_mfma_f32_16x16x32_bf16 v[20:23], v[96:99], v[96:99], v[20:23]
v_mfma_f32_16x16x32_bf16 v[20:23], v[100:103], v[100:103], v[20:23]
s_waitcnt vmcnt(1)
ds_read_b128 v[112:115], v50 offset:2048
ds_read_b128 v[116:119], v51 offset:2048
s_waitcnt lgkmcnt(2)
s_barrier
v_mfma_f32_16x16x32_bf16 v[20:23], v[104:107], v[104:107], v[20:23]
v_mfma_f32_16x16x32_bf16 v[20:23], v[108:111], v[108:111], v[20:23]
s_waitcnt lgkmcnt(0)
v_mfma_f32_16x16x32_bf16 v[20:23], v[112:115], v[112:115], v[20:23]
v_mfma_f32_16x16x32_bf16 v[20:23], v[116:119], v[116:119], v[20:23]
s_setprio 2
s_nop 6
v_mul_f32 v34, 0x3b124925, v22
v_cndmask_b32 v21, v20, v21, s[54:55]
v_mul_f32_e64 v32, -v34, v34
v_mov_b32_dpp v35, v22 quad_perm:[3,3,3,3] row_mask:0xf bank_mask:0xf
v_fmamk_f32 v21, v21, 0x3b124925, v32
v_cvt_pk_bf16_f32 v21, 0, abs(v21)
v_add_f32 v21, 0x3727c5ac, v21
v_cvt_pk_bf16_f32 v21, 0, v21
v_sqrt_f32 v21, v21
v_cvt_pk_bf16_f32 v32, 0, v34
v_cvt_pk_bf16_f32 v33, 0, v21
v_cvt_pk_bf16_f32 v36, v34, v21
v_rcp_f32 v21, v33
v_fma_f32 v23, -v32, v35, v23
s_mov_b32 exec_lo, 0x00300003
s_mov_b32 exec_hi, 0x30000300
s_cmp_lg_u32 s28, 0
s_cbranch_scc1 L_nok1
v_mul_f32 v23, v23, v21
v_ashrrev_i32 v33, 31, v23
v_bitop3_b32 v23, v33, s48, v23 bitop3:0x56
v_bfi_b32 v37, s47, v2, v23
ds_max_u64 v60, v[36:37] offset:28928
ds_add_rtn_u32 v34, v60, v19 offset:28936
L_nok1:
v_mul_f32_e64 v20, v32, v21
ds_write_b32 v16, v21 offset:28672
ds_write_b32 v16, v20 offset:28800
s_mov_b64 exec, -1
ds_read_b64 v[36:37], v60 offset:28928
ds_read2_b32 v[40:41], v17 offset0:0 offset1:4
s_cbranch_scc1 L_nokey
s_waitcnt lgkmcnt(1)
v_readfirstlane_b32 s58, v34
s_cmp_lt_u32 s58, 24
s_cbranch_scc1 L_nok2
buffer_store_dwordx4 v[36:39], v9, s[20:23], s50 offen sc1
L_nok2:
v_fmamk_f32 v22, v32, 0xc3e00000, v22
s_mov_b32 exec_lo, 0x00300003
s_mov_b32 exec_hi, 0x30000300
v_cvt_pk_bf16_f32 v22, v22, 0
ds_write_b32 v63, v22
s_mov_b64 exec, -1
L_nokey:
s_waitcnt lgkmcnt(0)
v_mul_f32 v24, v24, v40
v_mul_f32 v25, v25, v40
v_mul_f32 v26, v26, v41
v_mul_f32 v27, v27, v41
v_mul_f32 v28, v28, v40
v_mul_f32 v29, v29, v40
v_mul_f32 v30, v30, v41
v_mul_f32 v31, v31, v41
v_cvt_pk_bf16_f32 v44, v24, -v25
v_cvt_pk_bf16_f32 v45, v26, -v27
v_cvt_pk_bf16_f32 v46, v28, -v29
v_cvt_pk_bf16_f32 v47, v30, -v31
v_and_b32 v44, s56, v44
v_and_b32 v45, s56, v45
v_and_b32 v46, s57, v46
v_and_b32 v47, s57, v47
ds_write_b64 v18, v[44:45] offset:33280
ds_write_b64 v18, v[46:47] offset:35328
s_setprio 0
s_call_b64 s[92:93], L_addr2
s_waitcnt lgkmcnt(0)
s_barrier
s_branch L_prep
L_addr:
s_cmp_eq_u32 s28, 0
s_cselect_b32 s94, s26, s27
s_mov_b32 s95, s28
s_and_b32 s96, s24, 3
s_lshl_b32 s96, s96, 9
s_add_u32 s96, s96, s94
v_lshrrev_b32 v240, 5, v0
v_and_b32 v241, 31, v0
v_lshl_add_u32 v216, v240, 8, s96
v_add_u32 v217, 0x80, v216
v_min_u32 v218, 27, v241
v_cmp_gt_u32 vcc, 28, v241
s_cmp_lt_u32 s24, 4
s_cbranch_scc1 L_dir
v_sub_u32 v216, 0x800, v216
v_sub_u32 v217, 0x800, v217
v_and_b32 v216, 0x7ff, v216
v_add_u32 v218, 28, v218
s_cmp_lg_u32 s26, 0
s_cselect_b32 s96, 1, 0
s_xor_b32 s95, s95, s96
L_dir:
s_lshl_b32 s96, s95, 6
s_add_u32 s96, s96, 28672
s_mul_i32 s95, s95, 14
v_lshrrev_b32 v240, 3, v218
v_add_u32 v240, s95, v240
v_mov_b32 v233, 0x7fffffff
v_lshrrev_b32 v241, 7, v216
v_lshl_add_u32 v219, v241, 2, s96
v_lshlrev_b32 v242, 1, v241
v_bitop3_b32 v242, v242, 4, v218 bitop3:0x6a
v_lshlrev_b32 v243, 3, v241
v_bfi_b32 v242, 7, v242, v243
v_and_b32 v242, 63, v242
v_lshrrev_b32 v241, 3, v241
v_mad_u32_u24 v241, v241, 7, v240
v_lshl_add_u32 v242, v241, 6, v242
v_lshlrev_b32 v221, 4, v242
v_mad_u32_u24 v241, v216, 56, v218
v_lshlrev_b32 v241, 4, v241
v_cndmask_b32 v223, v233, v241, vcc
v_lshrrev_b32 v241, 7, v217
v_lshl_add_u32 v220, v241, 2, s96
v_lshlrev_b32 v242, 1, v241
v_bitop3_b32 v242, v242, 4, v218 bitop3:0x6a
v_lshlrev_b32 v243, 3, v241
v_bfi_b32 v242, 7, v242, v243
v_and_b32 v242, 63, v242
v_lshrrev_b32 v241, 3, v241
v_mad_u32_u24 v241, v241, 7, v240
v_lshl_add_u32 v242, v241, 6, v242
v_lshlrev_b32 v222, 4, v242
v_mad_u32_u24 v241, v217, 56, v218
v_lshlrev_b32 v241, 4, v241
v_cndmask_b32 v224, v233, v241, vcc
s_setpc_b64 s[92:93]
L_addr2:
v_lshlrev_b32 v231, 4, v0
v_and_b32 v240, 15, v0
v_cmp_lt_u32 s[88:89], 13, v240
v_cmp_eq_u32 vcc, 15, v240
s_and_b32 s96, s94, 15
s_lshl4_add_u32 s96, s96, s24
s_lshl_b32 s96, s96, 12
s_add_u32 s84, s96, 1048576
s_add_u32 s85, s84, 0x8000
s_lshl_b32 s86, s24, 13
s_add_u32 s86, s86, 62464
s_add_u32 s87, s86, 4096
s_pack_ll_b32_b16 s96, s30, s31
s_pack_hh_b32_b16 s97, s30, s31
v_mov_b32 v225, s96
v_mov_b32 v241, s97
v_cndmask_b32 v225, v225, v241, vcc
s_cmp_eq_u32 s24, 6
s_cselect_b64 s[88:89], vcc, s[88:89]
v_and_or_b32 v226, v231, 48, s86
v_and_b32 v241, 56, v0
v_lshl_add_u32 v226, v241, 3, v226
v_and_b32 v241, 4, v0
v_lshl_add_u32 v226, v241, 1, v226
s_lshr_b32 s95, s24, 1
s_mul_i32 s95, s95, 14
s_sub_u32 s96, 113, s95
s_bitcmp1_b32 s24, 0
s_cselect_b32 s95, s96, s95
s_cselect_b32 s96, -1, 0
v_xor_b32 v240, s96, v240
v_add_u32 v240, s95, v240
v_sub_u32 v241, 224, v240
v_lshrrev_b32 v242, 5, v241
v_and_b32 v242, 4, v242
v_xor_b32 v241, v241, v242
s_movk_i32 s96, 11520
v_and_or_b32 v242, v0, 16, s96
v_and_b32 v243, 48, v0
v_lshl_add_u32 v242, v243, 5, v242
v_add_lshl_u32 v227, v240, v242, 2
v_add_lshl_u32 v228, v241, v242, 2
s_lshl_b32 s96, s24, 11
s_and_b32 s97, s24, 1
s_lshl_b32 s97, s97, 6
s_add_u32 s96, s96, s97
s_add_u32 s96, s96, 46080
v_lshl_add_u32 v229, v0, 5, s96
v_and_or_b32 v229, v0, 16, v229
v_xor_b32 v230, 16, v229
v_mov_b32 v232, 4
s_setpc_b64 s[92:93]
L_mfma:
s_lshl2_add_u32 s29, s28, s24
s_lshr_b32 s32, s29, 1
s_mul_i32 s32, s32, 14
v_and_b32 v1, 15, v0
v_lshrrev_b32 v2, 4, v0
v_add_u32 v3, s32, v1
s_mov_b32 s34, 0x2f800000
v_mul_u32_u24 v4, 9586980, v3
v_mul_u32_u24 v5, 37449, v3
v_add_u32 v5, 0x8000, v5
v_lshrrev_b32 v5, 16, v5
v_add_u32 v4, v4, v5
v_add_lshl_u32 v5, v2, 12, 4
v_mul_lo_u32 v5, v5, v4
v_lshlrev_b32 v6, 6, v4
v_cvt_f32_u32 v4, v4
v_cvt_f32_i32 v100, v5
v_cvt_f32_i32 v6, v6
v_mul_f32 v4, s34, v4
v_mul_f32 v6, s34, v6
v_mov_b32 v96, 0
v_mul_f32 v97, 4.0, v4
v_cos_f32 v36, v6
v_add_f32 v98, v97, v97
v_pk_fma_f32 v[100:101], v[100:101], s[34:35], v[96:97] op_sel_hi:[0,0,1]
v_add_f32 v36, v36, v36
v_pk_add_f32 v[102:103], v[100:101], v[98:99] op_sel_hi:[1,0]
v_pk_add_f32 v[104:105], v[100:101], v[6:7] op_sel_hi:[1,0]
v_pk_add_f32 v[106:107], v[102:103], v[6:7] op_sel_hi:[1,0]
v_cos_f32 v64, v100
v_sin_f32 v65, v100
v_cos_f32 v66, v101
v_sin_f32 v67, v101
v_cos_f32 v68, v102
v_sin_f32 v69, v102
v_cos_f32 v70, v103
v_sin_f32 v71, v103
v_cos_f32 v72, v104
v_sin_f32 v73, v104
v_cos_f32 v74, v105
v_sin_f32 v75, v105
v_cos_f32 v76, v106
v_sin_f32 v77, v106
v_cos_f32 v78, v107
v_sin_f32_e64 v79, v107
s_waitcnt lgkmcnt(0)
s_load_dwordx2 s[30:31], s[20:21], 0
v_pk_fma_f32 v[56:57], v[36:37], v[64:65], v[72:73] op_sel_hi:[0,1,1] neg_lo:[0,0,1] neg_hi:[0,0,1]
v_pk_fma_f32 v[58:59], v[36:37], v[66:67], v[74:75] op_sel_hi:[0,1,1] neg_lo:[0,0,1] neg_hi:[0,0,1]
v_pk_fma_f32 v[60:61], v[36:37], v[68:69], v[76:77] op_sel_hi:[0,1,1] neg_lo:[0,0,1] neg_hi:[0,0,1]
v_pk_fma_f32 v[62:63], v[36:37], v[70:71], v[78:79] op_sel_hi:[0,1,1] neg_lo:[0,0,1] neg_hi:[0,0,1]
v_pk_fma_f32 v[80:81], v[36:37], v[72:73], v[64:65] op_sel_hi:[0,1,1] neg_lo:[0,0,1] neg_hi:[0,0,1]
v_pk_fma_f32 v[82:83], v[36:37], v[74:75], v[66:67] op_sel_hi:[0,1,1] neg_lo:[0,0,1] neg_hi:[0,0,1]
v_pk_fma_f32 v[84:85], v[36:37], v[76:77], v[68:69] op_sel_hi:[0,1,1] neg_lo:[0,0,1] neg_hi:[0,0,1]
v_pk_fma_f32 v[86:87], v[36:37], v[78:79], v[70:71] op_sel_hi:[0,1,1] neg_lo:[0,0,1] neg_hi:[0,0,1]
v_pk_fma_f32 v[48:49], v[36:37], v[56:57], v[64:65] op_sel_hi:[0,1,1] neg_lo:[0,0,1] neg_hi:[0,0,1]
v_pk_fma_f32 v[50:51], v[36:37], v[58:59], v[66:67] op_sel_hi:[0,1,1] neg_lo:[0,0,1] neg_hi:[0,0,1]
v_pk_fma_f32 v[52:53], v[36:37], v[60:61], v[68:69] op_sel_hi:[0,1,1] neg_lo:[0,0,1] neg_hi:[0,0,1]
v_pk_fma_f32 v[54:55], v[36:37], v[62:63], v[70:71] op_sel_hi:[0,1,1] neg_lo:[0,0,1] neg_hi:[0,0,1]
v_pk_fma_f32 v[88:89], v[36:37], v[80:81], v[72:73] op_sel_hi:[0,1,1] neg_lo:[0,0,1] neg_hi:[0,0,1]
v_pk_fma_f32 v[90:91], v[36:37], v[82:83], v[74:75] op_sel_hi:[0,1,1] neg_lo:[0,0,1] neg_hi:[0,0,1]
v_pk_fma_f32 v[92:93], v[36:37], v[84:85], v[76:77] op_sel_hi:[0,1,1] neg_lo:[0,0,1] neg_hi:[0,0,1]
v_pk_fma_f32 v[94:95], v[36:37], v[86:87], v[78:79] op_sel_hi:[0,1,1] neg_lo:[0,0,1] neg_hi:[0,0,1]
v_pk_fma_f32 v[40:41], v[36:37], v[48:49], v[56:57] op_sel_hi:[0,1,1] neg_lo:[0,0,1] neg_hi:[0,0,1]
v_pk_fma_f32 v[42:43], v[36:37], v[50:51], v[58:59] op_sel_hi:[0,1,1] neg_lo:[0,0,1] neg_hi:[0,0,1]
v_pk_fma_f32 v[44:45], v[36:37], v[52:53], v[60:61] op_sel_hi:[0,1,1] neg_lo:[0,0,1] neg_hi:[0,0,1]
v_pk_fma_f32 v[46:47], v[36:37], v[54:55], v[62:63] op_sel_hi:[0,1,1] neg_lo:[0,0,1] neg_hi:[0,0,1]
v_cvt_pk_bf16_f32 v14, v64, v66
v_cvt_pk_bf16_f32 v28, v65, v67
v_cvt_pk_bf16_f32 v15, v68, v70
v_cvt_pk_bf16_f32 v29, v69, v71
v_cvt_pk_bf16_f32 v16, v72, v74
v_cvt_pk_bf16_f32 v30, v73, v75
v_cvt_pk_bf16_f32 v17, v76, v78
v_cvt_pk_bf16_f32 v31, v77, v79
v_cvt_pk_bf16_f32 v12, v56, v58
v_cvt_pk_bf16_f32 v26, v57, v59
v_cvt_pk_bf16_f32 v13, v60, v62
v_cvt_pk_bf16_f32 v27, v61, v63
v_cvt_pk_bf16_f32 v18, v80, v82
v_cvt_pk_bf16_f32 v32, v81, v83
v_cvt_pk_bf16_f32 v19, v84, v86
v_cvt_pk_bf16_f32 v33, v85, v87
v_cvt_pk_bf16_f32 v10, v48, v50
v_cvt_pk_bf16_f32 v24, v49, v51
v_cvt_pk_bf16_f32 v11, v52, v54
v_cvt_pk_bf16_f32 v25, v53, v55
v_cvt_pk_bf16_f32 v20, v88, v90
v_cvt_pk_bf16_f32 v34, v89, v91
v_cvt_pk_bf16_f32 v21, v92, v94
v_cvt_pk_bf16_f32 v35, v93, v95
v_cvt_pk_bf16_f32 v8, v40, v42
v_cvt_pk_bf16_f32 v22, v41, v43
v_cvt_pk_bf16_f32 v9, v44, v46
v_cvt_pk_bf16_f32 v23, v45, v47
v_add_f32 v5, v4, v4
v_add_f32 v6, v5, v4
v_mov_b32 v128, 1.0
v_mov_b32 v130, 0
v_cos_f32 v129, v4
v_sin_f32 v131, v4
v_cos_f32 v132, v5
v_sin_f32 v134, v5
v_cos_f32 v133, v6
v_sin_f32 v135, v6
v_lshrrev_b32 v4, 3, v0
v_lshlrev_b32 v5, 1, v0
v_bitop3_b32 v4, v5, 4, v4 bitop3:0x6a
v_and_b32 v6, 3, v0
v_lshl_add_u32 v4, v6, 3, v4
s_and_b32 s33, s24, 1
s_mul_i32 s36, s33, 14336
v_and_or_b32 v5, v5, 8, s36
v_lshl_add_u32 v4, v4, 4, v5
s_lshr_b32 s36, s24, 1
s_lshl_b32 s36, s36, 13
s_lshl_b32 s33, s33, 10
s_add_u32 s36, s36, s33
s_add_u32 s36, s36, 95232
v_lshl_add_u32 v5, v0, 4, s36
v_cmp_eq_u32 vcc, 0, v3
v_mov_b32 v7, 111616
s_lshl_b32 s36, s24, 12
s_add_u32 s36, s36, 95232
v_lshl_add_u32 v6, v0, 4, s36
v_cndmask_b32 v7, v5, v7, vcc
s_waitcnt lgkmcnt(0)
s_cmp_gt_u32 s29, 0
s_cbranch_scc1 L_npk
v_lshrrev_b32 v80, 3, v0
v_and_b32 v81, 7, v0
v_lshlrev_b32 v81, 4, v81
v_lshl_add_u32 v80, v80, 13, v81
s_lshl_b32 s36, s26, 7
s_lshl_b32 s37, s29, 16
s_add_u32 s36, s36, s37
s_add_u32 s36, s36, 65536
v_mov_b32 v86, s30
v_mov_b32 v87, s31
buffer_store_dwordx4 v[84:87], v80, s[20:23], s36 offen sc1
L_npk:
s_add_u32 s30, s30, 2654435769
s_add_u32 s31, s31, 2135587861
v_cmp_lt_u32 vcc, 47, v0
s_cmp_eq_u32 s29, 6
s_cselect_b32 s36, 0xffff0000, -1
v_lshlrev_b32 v207, 4, v0
v_cndmask_b32 v206, 0, -1, vcc
v_and_b32 v205, s36, v206
s_lshl_b32 s37, s24, 13
s_add_u32 s37, s37, 62464
s_movk_i32 s38, 80
v_and_or_b32 v208, v0, 48, s37
v_mad_u32_u24 v208, v1, s38, v208
v_lshrrev_b32 v204, 2, v0
v_and_b32 v209, 48, v207
v_mad_u32_u24 v210, v204, s38, v209
v_add_u32 v210, s37, v210
v_lshl_add_u32 v204, v204, 16, v209
s_lshl_b32 s48, s29, 12
s_lshl_b32 s49, s26, 6
s_add_u32 s48, s48, s49
s_add_u32 s48, s48, 1048576
s_add_u32 s49, s48, 0x8000
s_cmp_eq_u32 s28, 0
s_cselect_b32 s44, s26, s27
s_lshr_b32 s45, s44, 4
v_lshl_add_u32 v80, v1, 3, s45
v_cvt_f32_u32 v80, v80
v_mul_f32 v80, 0x3c000000, v80
s_lshl_b32 s36, s24, 4
v_lshrrev_b32 v81, 3, v0
v_and_or_b32 v81, v81, 6, s36
v_cmp_eq_u32 vcc, 0, v81
v_cvt_f32_u32 v81, v81
v_mul_f32 v81, v80, v81
s_bitcmp1_b32 s45, 0
s_cselect_b32 s36, -1.0, 1.0
s_mov_b32 s43, 0x3d800000
v_mov_b32 v82, s36
v_cos_f32 v83, v81
v_sin_f32 v88, v81
v_add_f32 v81, v81, v80
v_cndmask_b32 v88, v88, v82, vcc
v_mul_f32 v83, s43, v83
v_mul_f32 v88, s43, v88
v_cvt_pk_bf16_f32 v212, v83, v88
v_cos_f32 v83, v81
v_sin_f32 v88, v81
v_fmac_f32 v81, 0x40e00000, v80
v_mul_f32 v83, s43, v83
v_mul_f32 v88, s43, v88
v_cvt_pk_bf16_f32 v213, v83, v88
v_cos_f32 v83, v81
v_sin_f32 v88, v81
v_add_f32 v81, v81, v80
v_mul_f32 v83, s43, v83
v_mul_f32 v88, s43, v88
v_cvt_pk_bf16_f32 v214, v83, v88
v_cos_f32 v83, v81
v_sin_f32 v88, v81
s_lshl_b32 s36, s24, 10
v_mul_f32 v83, s43, v83
v_mul_f32 v88, s43, v88
v_cvt_pk_bf16_f32 v215, v83, v88
v_add_u32_e64 v211, s36, v207
s_setprio 1
s_barrier
ds_read_b64_tr_b16 v[40:41], v4 offset:0
ds_read_b64_tr_b16 v[42:43], v4 offset:1024
ds_read_b64_tr_b16 v[44:45], v4 offset:2048
ds_read_b64_tr_b16 v[46:47], v4 offset:3072
ds_read_b64_tr_b16 v[48:49], v4 offset:4096
ds_read_b64_tr_b16 v[50:51], v4 offset:5120
ds_read_b64_tr_b16 v[54:55], v4 offset:512
ds_read_b64_tr_b16 v[56:57], v4 offset:1536
s_waitcnt lgkmcnt(6)
v_mfma_f32_16x16x32_bf16 v[96:99], v[40:43], v[8:11], 0
ds_read_b64_tr_b16 v[58:59], v4 offset:2560
v_mfma_f32_16x16x32_bf16 v[100:103], v[40:43], v[22:25], 0
ds_read_b64_tr_b16 v[60:61], v4 offset:3584
s_waitcnt lgkmcnt(6)
v_mfma_f32_16x16x32_bf16 v[96:99], v[44:47], v[12:15], v[96:99]
ds_read_b64_tr_b16 v[62:63], v4 offset:4608
v_mfma_f32_16x16x32_bf16 v[100:103], v[44:47], v[26:29], v[100:103]
ds_read_b64_tr_b16 v[64:65], v4 offset:5632
s_waitcnt lgkmcnt(6)
v_mfma_f32_16x16x32_bf16 v[96:99], v[48:51], v[16:19], v[96:99]
ds_read_b64_tr_b16 v[68:69], v4 offset:7168
v_mfma_f32_16x16x32_bf16 v[100:103], v[48:51], v[30:33], v[100:103]
ds_read_b64_tr_b16 v[70:71], v4 offset:8192
s_waitcnt lgkmcnt(6)
v_mfma_f32_16x16x32_bf16 v[104:107], v[54:57], v[8:11], 0
ds_read_b64_tr_b16 v[72:73], v4 offset:9216
v_mfma_f32_16x16x32_bf16 v[108:111], v[54:57], v[22:25], 0
ds_read_b64_tr_b16 v[74:75], v4 offset:10240
s_waitcnt lgkmcnt(6)
v_mfma_f32_16x16x32_bf16 v[104:107], v[58:61], v[12:15], v[104:107]
ds_read_b64_tr_b16 v[76:77], v4 offset:11264
v_mfma_f32_16x16x32_bf16 v[108:111], v[58:61], v[26:29], v[108:111]
ds_read_b64_tr_b16 v[78:79], v4 offset:12288
s_waitcnt lgkmcnt(6)
v_mfma_f32_16x16x32_bf16 v[104:107], v[62:65], v[16:19], v[104:107]
ds_read_b64_tr_b16 v[52:53], v4 offset:6144
v_mfma_f32_16x16x32_bf16 v[108:111], v[62:65], v[30:33], v[108:111]
ds_read_b64_tr_b16 v[66:67], v4 offset:6656
s_waitcnt lgkmcnt(6)
v_mfma_f32_16x16x32_bf16 v[112:115], v[68:71], v[8:11], 0
ds_read_b64_tr_b16 v[82:83], v4 offset:7680
v_mfma_f32_16x16x32_bf16 v[116:119], v[68:71], v[22:25], 0
ds_read_b64_tr_b16 v[84:85], v4 offset:8704
s_waitcnt lgkmcnt(6)
v_mfma_f32_16x16x32_bf16 v[112:115], v[72:75], v[12:15], v[112:115]
ds_read_b64_tr_b16 v[86:87], v4 offset:9728
v_mfma_f32_16x16x32_bf16 v[116:119], v[72:75], v[26:29], v[116:119]
ds_read_b64_tr_b16 v[88:89], v4 offset:10752
s_waitcnt lgkmcnt(6)
v_mfma_f32_16x16x32_bf16 v[112:115], v[76:79], v[16:19], v[112:115]
ds_read_b64_tr_b16 v[90:91], v4 offset:11776
v_mfma_f32_16x16x32_bf16 v[116:119], v[76:79], v[30:33], v[116:119]
ds_read_b64_tr_b16 v[92:93], v4 offset:12800
s_waitcnt lgkmcnt(7)
v_mfma_f32_16x16x16_bf16 v[96:99], v[52:53], v[20:21], v[96:99]
ds_read_b64_tr_b16 v[80:81], v4 offset:13312
v_mfma_f32_16x16x16_bf16 v[100:103], v[52:53], v[34:35], v[100:103]
ds_read_b64_tr_b16 v[94:95], v4 offset:13824
s_waitcnt lgkmcnt(8)
v_mfma_f32_16x16x16_bf16 v[104:107], v[66:67], v[20:21], v[104:107]
ds_write_b128 v211, v[212:215] offset:29184
v_mfma_f32_16x16x16_bf16 v[108:111], v[66:67], v[34:35], v[108:111]
s_waitcnt lgkmcnt(7)
v_mfma_f32_16x16x32_bf16 v[120:123], v[82:85], v[8:11], 0
v_mfma_f32_16x16x32_bf16 v[124:127], v[82:85], v[22:25], 0
s_waitcnt lgkmcnt(1)
v_pk_mul_f32 v[40:41], v[96:97], v[128:129]
v_pk_mul_f32 v[42:43], v[100:101], v[128:129]
v_pk_mul_f32 v[54:55], v[104:105], v[128:129]
s_nop 0
v_pk_mul_f32 v[56:57], v[108:109], v[128:129]
v_pk_fma_f32 v[40:41], v[100:101], v[130:131], v[40:41] neg_lo:[1,0,0] neg_hi:[1,0,0]
v_pk_fma_f32 v[42:43], v[96:97], v[130:131], v[42:43]
v_pk_fma_f32 v[54:55], v[108:109], v[130:131], v[54:55] neg_lo:[1,0,0] neg_hi:[1,0,0]
v_pk_fma_f32 v[56:57], v[104:105], v[130:131], v[56:57]
v_pk_fma_f32 v[44:45], v[98:99], v[132:133], v[40:41]
v_pk_fma_f32 v[46:47], v[102:103], v[132:133], v[42:43]
v_pk_fma_f32 v[58:59], v[106:107], v[132:133], v[54:55]
v_pk_fma_f32 v[60:61], v[110:111], v[132:133], v[56:57]
v_pk_fma_f32 v[44:45], v[102:103], v[134:135], v[44:45] neg_lo:[1,0,0] neg_hi:[1,0,0]
v_pk_fma_f32 v[46:47], v[98:99], v[134:135], v[46:47]
v_pk_fma_f32 v[58:59], v[110:111], v[134:135], v[58:59] neg_lo:[1,0,0] neg_hi:[1,0,0]
v_pk_fma_f32 v[60:61], v[106:107], v[134:135], v[60:61]
v_pk_fma_f32 v[40:41], v[40:41], 2.0, v[44:45] op_sel_hi:[1,0,1] neg_lo:[0,0,1] neg_hi:[0,0,1]
v_pk_fma_f32 v[42:43], v[42:43], 2.0, v[46:47] op_sel_hi:[1,0,1] neg_lo:[0,0,1] neg_hi:[0,0,1]
v_pk_fma_f32 v[54:55], v[54:55], 2.0, v[58:59] op_sel_hi:[1,0,1] neg_lo:[0,0,1] neg_hi:[0,0,1]
v_pk_fma_f32 v[56:57], v[56:57], 2.0, v[60:61] op_sel_hi:[1,0,1] neg_lo:[0,0,1] neg_hi:[0,0,1]
v_pk_add_f32 v[96:97], v[44:45], v[44:45] op_sel:[0,1] op_sel_hi:[0,1] neg_hi:[0,1]
v_pk_add_f32 v[98:99], v[46:47], v[46:47] op_sel:[1,0] op_sel_hi:[1,0] neg_hi:[0,1]
v_pk_add_f32 v[104:105], v[58:59], v[58:59] op_sel:[0,1] op_sel_hi:[0,1] neg_hi:[0,1]
v_pk_add_f32 v[106:107], v[60:61], v[60:61] op_sel:[1,0] op_sel_hi:[1,0] neg_hi:[0,1]
v_pk_add_f32 v[100:101], v[40:41], v[42:43] op_sel:[0,1] op_sel_hi:[0,1] neg_hi:[0,1]
v_pk_add_f32 v[102:103], v[40:41], v[42:43] op_sel:[1,0] op_sel_hi:[1,0] neg_lo:[0,1]
v_pk_add_f32 v[108:109], v[54:55], v[56:57] op_sel:[0,1] op_sel_hi:[0,1] neg_hi:[0,1]
v_pk_add_f32 v[110:111], v[54:55], v[56:57] op_sel:[1,0] op_sel_hi:[1,0] neg_lo:[0,1]
v_mfma_f32_16x16x32_bf16 v[120:123], v[86:89], v[12:15], v[120:123]
v_cvt_pk_bf16_f32 v136, v96, v98
v_cvt_pk_bf16_f32 v137, v104, v106
v_mfma_f32_16x16x32_bf16 v[124:127], v[86:89], v[26:29], v[124:127]
v_cvt_pk_bf16_f32 v140, v97, v99
v_cvt_pk_bf16_f32 v141, v105, v107
v_mfma_f32_16x16x32_bf16 v[120:123], v[90:93], v[16:19], v[120:123]
ds_write_b64 v7, v[136:137] offset:0
v_mfma_f32_16x16x32_bf16 v[124:127], v[90:93], v[30:33], v[124:127]
v_cvt_pk_bf16_f32 v144, v100, v102
v_cvt_pk_bf16_f32 v145, v108, v110
v_mfma_f32_16x16x16_bf16 v[112:115], v[80:81], v[20:21], v[112:115]
ds_write_b64 v5, v[140:141] offset:2048
v_mfma_f32_16x16x16_bf16 v[116:119], v[80:81], v[34:35], v[116:119]
v_cvt_pk_bf16_f32 v148, v101, v103
v_cvt_pk_bf16_f32 v149, v109, v111
v_mfma_f32_16x16x16_bf16 v[120:123], v[94:95], v[20:21], v[120:123]
ds_write_b64 v5, v[144:145] offset:4096
v_mfma_f32_16x16x16_bf16 v[124:127], v[94:95], v[34:35], v[124:127]
s_nop 0
v_pk_mul_f32 v[40:41], v[112:113], v[128:129]
s_nop 0
v_pk_mul_f32 v[42:43], v[116:117], v[128:129]
v_pk_fma_f32 v[40:41], v[116:117], v[130:131], v[40:41] neg_lo:[1,0,0] neg_hi:[1,0,0]
v_pk_fma_f32 v[42:43], v[112:113], v[130:131], v[42:43]
ds_write_b64 v5, v[148:149] offset:6144
v_pk_fma_f32 v[44:45], v[114:115], v[132:133], v[40:41]
v_pk_fma_f32 v[46:47], v[118:119], v[132:133], v[42:43]
v_pk_mul_f32 v[54:55], v[120:121], v[128:129]
v_pk_mul_f32 v[56:57], v[124:125], v[128:129]
v_pk_fma_f32 v[54:55], v[124:125], v[130:131], v[54:55] neg_lo:[1,0,0] neg_hi:[1,0,0]
v_pk_fma_f32 v[56:57], v[120:121], v[130:131], v[56:57]
v_pk_fma_f32 v[44:45], v[118:119], v[134:135], v[44:45] neg_lo:[1,0,0] neg_hi:[1,0,0]
v_pk_fma_f32 v[46:47], v[114:115], v[134:135], v[46:47]
v_pk_fma_f32 v[58:59], v[122:123], v[132:133], v[54:55]
v_pk_fma_f32 v[60:61], v[126:127], v[132:133], v[56:57]
v_pk_fma_f32 v[58:59], v[126:127], v[134:135], v[58:59] neg_lo:[1,0,0] neg_hi:[1,0,0]
v_pk_fma_f32 v[60:61], v[122:123], v[134:135], v[60:61]
v_pk_add_f32 v[112:113], v[44:45], v[44:45] op_sel:[0,1] op_sel_hi:[0,1] neg_hi:[0,1]
v_pk_add_f32 v[114:115], v[46:47], v[46:47] op_sel:[1,0] op_sel_hi:[1,0] neg_hi:[0,1]
v_pk_add_f32 v[120:121], v[58:59], v[58:59] op_sel:[0,1] op_sel_hi:[0,1] neg_hi:[0,1]
v_pk_add_f32 v[122:123], v[60:61], v[60:61] op_sel:[1,0] op_sel_hi:[1,0] neg_hi:[0,1]
v_cvt_pk_bf16_f32 v138, v112, v114
v_cvt_pk_bf16_f32 v139, v120, v122
ds_write_b64 v7, v[138:139] offset:8
v_cvt_pk_bf16_f32 v142, v113, v115
v_cvt_pk_bf16_f32 v143, v121, v123
v_pk_fma_f32 v[40:41], v[40:41], 2.0, v[44:45] op_sel_hi:[1,0,1] neg_lo:[0,0,1] neg_hi:[0,0,1]
v_pk_fma_f32 v[42:43], v[42:43], 2.0, v[46:47] op_sel_hi:[1,0,1] neg_lo:[0,0,1] neg_hi:[0,0,1]
v_pk_fma_f32 v[54:55], v[54:55], 2.0, v[58:59] op_sel_hi:[1,0,1] neg_lo:[0,0,1] neg_hi:[0,0,1]
v_pk_fma_f32 v[56:57], v[56:57], 2.0, v[60:61] op_sel_hi:[1,0,1] neg_lo:[0,0,1] neg_hi:[0,0,1]
ds_write_b64 v5, v[142:143] offset:2056
v_pk_add_f32 v[116:117], v[40:41], v[42:43] op_sel:[0,1] op_sel_hi:[0,1] neg_hi:[0,1]
v_pk_add_f32 v[118:119], v[40:41], v[42:43] op_sel:[1,0] op_sel_hi:[1,0] neg_lo:[0,1]
v_pk_add_f32 v[124:125], v[54:55], v[56:57] op_sel:[0,1] op_sel_hi:[0,1] neg_hi:[0,1]
v_pk_add_f32 v[126:127], v[54:55], v[56:57] op_sel:[1,0] op_sel_hi:[1,0] neg_lo:[0,1]
v_cvt_pk_bf16_f32 v146, v116, v118
v_cvt_pk_bf16_f32 v147, v124, v126
ds_write_b64 v5, v[146:147] offset:4104
v_cvt_pk_bf16_f32 v150, v117, v119
v_cvt_pk_bf16_f32 v151, v125, v127
ds_write_b64 v5, v[150:151] offset:6152
s_waitcnt lgkmcnt(0)
s_barrier
ds_read_b128 v[40:43], v6 offset:0
ds_read_b128 v[8:11], v207 offset:33280
ds_read_b128 v[16:19], v207 offset:35328
ds_read_b128 v[44:47], v6 offset:1024
ds_read_b128 v[12:15], v207 offset:34304
ds_read_b128 v[20:23], v207 offset:36352
ds_read_b128 v[48:51], v6 offset:2048
ds_read_b128 v[52:55], v6 offset:3072
s_waitcnt lgkmcnt(6)
v_mfma_f32_16x16x32_bf16 v[56:59], v[40:43], v[8:11], 0
s_waitcnt lgkmcnt(5)
v_mfma_f32_16x16x32_bf16 v[60:63], v[40:43], v[16:19], 0
s_waitcnt lgkmcnt(3)
v_mfma_f32_16x16x32_bf16 v[56:59], v[44:47], v[12:15], v[56:59]
s_waitcnt lgkmcnt(2)
v_mfma_f32_16x16x32_bf16 v[60:63], v[44:47], v[20:23], v[60:63]
s_waitcnt lgkmcnt(1)
v_mfma_f32_16x16x32_bf16 v[64:67], v[48:51], v[8:11], 0
v_mfma_f32_16x16x32_bf16 v[68:71], v[48:51], v[16:19], 0
s_waitcnt lgkmcnt(0)
v_mfma_f32_16x16x32_bf16 v[64:67], v[52:55], v[12:15], v[64:67]
v_mfma_f32_16x16x32_bf16 v[68:71], v[52:55], v[20:23], v[68:71]
v_cvt_pk_bf16_f32 v33, v58, v59
v_cvt_pk_bf16_f32 v32, v56, v57
v_cvt_pk_bf16_f32 v35, v62, v63
v_cvt_pk_bf16_f32 v34, v60, v61
v_bfi_b32 v33, v205, s30, v33
v_bfi_b32 v35, v205, s31, v35
ds_write_b128 v208, v[32:35] offset:0
ds_read_b128 v[24:27], v210 offset:0
v_cvt_pk_bf16_f32 v37, v66, v67
v_cvt_pk_bf16_f32 v36, v64, v65
v_cvt_pk_bf16_f32 v39, v70, v71
v_cvt_pk_bf16_f32 v38, v68, v69
v_bfi_b32 v37, v205, s30, v37
v_bfi_b32 v39, v205, s31, v39
ds_write_b128 v208, v[36:39] offset:2048
ds_read_b128 v[28:31], v210 offset:2048
s_waitcnt lgkmcnt(2)
buffer_store_dwordx4 v[24:27], v204, s[20:23], s48 offen sc1
s_waitcnt lgkmcnt(0)
buffer_store_dwordx4 v[28:31], v204, s[20:23], s49 offen sc1
s_setprio 0
s_call_b64 s[92:93], L_addr
s_call_b64 s[92:93], L_addr2
L_prep:
v_lshlrev_b32_e64 v7, 7, v0
s_cmp_lg_u32 s24, 7
s_cbranch_scc1 L_kia
s_lshl_b32 s59, s25, 13
s_add_u32 s59, s59, 65536
buffer_load_dwordx4 v[84:87], v7, s[20:23], s59 offen sc1
L_kia:
ds_read2_b32 v[72:73], v219 offset0:0 offset1:32
ds_read_b128 v[76:79], v221
ds_read2_b32 v[74:75], v220 offset0:0 offset1:32
ds_read_b128 v[80:83], v222
ds_read_b128 v[8:11], v231 offset:29184
ds_read_b128 v[12:15], v231 offset:30208
ds_read_b128 v[16:19], v231 offset:31232
ds_read_b128 v[20:23], v231 offset:32256
s_mov_b32 m0, s86
v_mov_b32 v4, 0
s_waitcnt lgkmcnt(0)
v_lshlrev_b32 v96, 16, v76
v_and_b32 v97, 0xffff0000, v76
v_lshlrev_b32 v98, 16, v77
v_and_b32 v99, 0xffff0000, v77
v_lshlrev_b32 v100, 16, v78
v_and_b32 v101, 0xffff0000, v78
v_lshlrev_b32 v102, 16, v79
v_and_b32 v103, 0xffff0000, v79
v_lshlrev_b32 v104, 16, v80
v_and_b32 v105, 0xffff0000, v80
v_lshlrev_b32 v106, 16, v81
v_and_b32 v107, 0xffff0000, v81
v_lshlrev_b32 v108, 16, v82
v_and_b32 v109, 0xffff0000, v82
v_lshlrev_b32_e64 v110, 16, v83
v_and_b32 v111, 0xffff0000, v83
s_mov_b32 s36, 0xbfb8aa3b
v_pk_fma_f32 v[112:113], v[96:97], v[72:73], v[72:73] op_sel:[0,0,1] op_sel_hi:[1,0,1] neg_lo:[0,0,1] neg_hi:[0,0,1]
v_pk_fma_f32 v[114:115], v[98:99], v[72:73], v[72:73] op_sel:[0,0,1] op_sel_hi:[1,0,1] neg_lo:[0,0,1] neg_hi:[0,0,1]
v_pk_fma_f32 v[116:117], v[100:101], v[72:73], v[72:73] op_sel:[0,0,1] op_sel_hi:[1,0,1] neg_lo:[0,0,1] neg_hi:[0,0,1]
v_pk_fma_f32 v[118:119], v[102:103], v[72:73], v[72:73] op_sel:[0,0,1] op_sel_hi:[1,0,1] neg_lo:[0,0,1] neg_hi:[0,0,1]
v_pk_fma_f32 v[120:121], v[104:105], v[74:75], v[74:75] op_sel:[0,0,1] op_sel_hi:[1,0,1] neg_lo:[0,0,1] neg_hi:[0,0,1]
v_pk_fma_f32 v[122:123], v[106:107], v[74:75], v[74:75] op_sel:[0,0,1] op_sel_hi:[1,0,1] neg_lo:[0,0,1] neg_hi:[0,0,1]
v_pk_fma_f32 v[124:125], v[108:109], v[74:75], v[74:75] op_sel:[0,0,1] op_sel_hi:[1,0,1] neg_lo:[0,0,1] neg_hi:[0,0,1]
v_pk_fma_f32 v[126:127], v[110:111], v[74:75], v[74:75] op_sel:[0,0,1] op_sel_hi:[1,0,1] neg_lo:[0,0,1] neg_hi:[0,0,1]
v_pk_mul_f32 v[128:129], v[112:113], s[36:37] op_sel_hi:[1,0]
v_pk_mul_f32 v[130:131], v[114:115], s[36:37] op_sel_hi:[1,0]
v_pk_mul_f32 v[132:133], v[116:117], s[36:37] op_sel_hi:[1,0]
v_pk_mul_f32 v[134:135], v[118:119], s[36:37] op_sel_hi:[1,0]
v_pk_mul_f32 v[136:137], v[120:121], s[36:37] op_sel_hi:[1,0]
v_pk_mul_f32 v[138:139], v[122:123], s[36:37] op_sel_hi:[1,0]
v_pk_mul_f32 v[140:141], v[124:125], s[36:37] op_sel_hi:[1,0]
v_pk_mul_f32 v[142:143], v[126:127], s[36:37] op_sel_hi:[1,0]
s_cmp_lt_u32 s24, 4
s_cbranch_scc0 L_g2
s_barrier
buffer_load_dwordx4 v231, s[20:23], s84 offen offset:0 sc1 lds
buffer_load_dwordx4 v231, s[20:23], s84 offen offset:1024 sc1 lds
buffer_load_dwordx4 v231, s[20:23], s84 offen offset:2048 sc1 lds
buffer_load_dwordx4 v231, s[20:23], s84 offen offset:3072 sc1 lds
L_g2:
v_exp_f32 v128, v128
v_exp_f32 v129, v129
v_exp_f32 v130, v130
v_exp_f32 v131, v131
v_exp_f32 v132, v132
v_exp_f32 v133, v133
v_exp_f32 v134, v134
v_exp_f32 v135, v135
v_exp_f32 v136, v136
v_exp_f32 v137, v137
v_exp_f32 v138, v138
v_exp_f32 v139, v139
v_exp_f32 v140, v140
v_exp_f32 v141, v141
v_exp_f32 v142, v142
v_exp_f32_e64 v143, v143
s_mov_b32 s36, 0x3d800000
v_pk_fma_f32 v[128:129], v[128:129], s[36:37], s[36:37] op_sel_hi:[1,0,0]
v_pk_fma_f32 v[130:131], v[130:131], s[36:37], s[36:37] op_sel_hi:[1,0,0]
v_pk_fma_f32 v[132:133], v[132:133], s[36:37], s[36:37] op_sel_hi:[1,0,0]
v_pk_fma_f32 v[134:135], v[134:135], s[36:37], s[36:37] op_sel_hi:[1,0,0]
v_pk_fma_f32 v[136:137], v[136:137], s[36:37], s[36:37] op_sel_hi:[1,0,0]
v_pk_fma_f32 v[138:139], v[138:139], s[36:37], s[36:37] op_sel_hi:[1,0,0]
v_pk_fma_f32 v[140:141], v[140:141], s[36:37], s[36:37] op_sel_hi:[1,0,0]
v_pk_fma_f32 v[142:143], v[142:143], s[36:37], s[36:37] op_sel_hi:[1,0,0]
s_cmp_lg_u32 s24, 7
s_cbranch_scc1 L_gx
s_mov_b32 s38, 0
s_waitcnt vmcnt(0)
L_gp:
v_cmp_ne_u64 vcc, s[30:31], v[86:87]
s_and_b64 exec, exec, vcc
s_cbranch_scc0 L_gy
buffer_load_dwordx4 v[84:87], v7, s[20:23], s59 offen sc1
s_add_u32 s38, s38, 1
s_cmp_lt_u32 s38, 524288
s_waitcnt vmcnt(0)
s_cbranch_scc1 L_gp
L_gy:
s_mov_b64 exec, -1
L_gx:
s_cmp_lt_u32 s24, 4
s_cbranch_scc0 L_m3
s_mov_b32 m0, s87
s_nop 0
buffer_load_dwordx4 v231, s[20:23], s85 offen offset:0 sc1 lds
buffer_load_dwordx4 v231, s[20:23], s85 offen offset:1024 sc1 lds
buffer_load_dwordx4 v231, s[20:23], s85 offen offset:2048 sc1 lds
buffer_load_dwordx4 v231, s[20:23], s85 offen offset:3072 sc1 lds
L_m3:
s_cmp_lg_u32 s24, 7
s_cbranch_scc1 L_noidx
v_max_u32_dpp v85, v85, v85 quad_perm:[1,0,3,2] row_mask:0xf bank_mask:0xf
s_nop 1
v_max_u32_dpp v85, v85, v85 quad_perm:[2,3,0,1] row_mask:0xf bank_mask:0xf
s_nop 1
v_max_u32_dpp v85, v85, v85 row_half_mirror row_mask:0xf bank_mask:0xf
s_nop 1
v_max_u32_dpp v85, v85, v85 row_mirror row_mask:0xf bank_mask:0xf
s_nop 0
v_readlane_b32 s52, v85, 0
v_readlane_b32 s53, v85, 16
v_readlane_b32 s54, v85, 32
v_readlane_b32 s55, v85, 48
s_max_u32 s52, s52, s53
s_max_u32 s54, s54, s55
s_max_u32 s52, s52, s54
s_and_b32 s52, s52, 0x7ff
v_mov_b32 v84, s52
v_mov_b32 v232, 0
L_noidx:
v_rcp_f32 v128, v128
v_rcp_f32 v129, v129
v_rcp_f32 v130, v130
v_rcp_f32 v131, v131
v_rcp_f32 v132, v132
v_rcp_f32 v133, v133
v_rcp_f32 v134, v134
v_rcp_f32 v135, v135
v_rcp_f32 v136, v136
v_rcp_f32 v137, v137
v_rcp_f32 v138, v138
v_rcp_f32 v139, v139
v_rcp_f32 v140, v140
v_rcp_f32 v141, v141
v_rcp_f32 v142, v142
v_rcp_f32 v143, v143
s_cmp_lt_u32 s24, 4
s_cbranch_scc1 L_g4
s_barrier
buffer_load_dwordx4 v231, s[20:23], s84 offen offset:0 sc1 lds
buffer_load_dwordx4 v231, s[20:23], s84 offen offset:1024 sc1 lds
buffer_load_dwordx4 v231, s[20:23], s84 offen offset:2048 sc1 lds
buffer_load_dwordx4 v231, s[20:23], s84 offen offset:3072 sc1 lds
L_g4:
s_cmp_lt_u32 s24, 4
s_cbranch_scc1 L_m4
s_mov_b32 m0, s87
s_nop 0
buffer_load_dwordx4 v231, s[20:23], s85 offen offset:0 sc1 lds
buffer_load_dwordx4 v231, s[20:23], s85 offen offset:1024 sc1 lds
buffer_load_dwordx4 v231, s[20:23], s85 offen offset:2048 sc1 lds
buffer_load_dwordx4 v231, s[20:23], s85 offen offset:3072 sc1 lds
L_m4:
s_mov_b32 s33, 0
L_hchk0:
s_waitcnt vmcnt(7)
ds_read_b64_tr_b16 v[24:25], v226 offset:0
ds_read_b64_tr_b16 v[26:27], v226 offset:512
s_waitcnt vmcnt(6)
ds_read_b64_tr_b16 v[28:29], v226 offset:1024
ds_read_b64_tr_b16 v[30:31], v226 offset:1536
s_waitcnt vmcnt(5)
ds_read_b64_tr_b16 v[32:33], v226 offset:2048
ds_read_b64_tr_b16 v[34:35], v226 offset:2560
s_waitcnt lgkmcnt(4)
v_mfma_f32_16x16x32_bf16 v[56:59], v[8:11], v[24:27], 0
v_bitop3_b32 v68, v24, v25, v225 bitop3:0x7e
v_bitop3_b32 v71, v26, v27, v225 bitop3:0x7e
v_or_b32 v69, v68, v71
s_waitcnt vmcnt(4)
ds_read_b64_tr_b16 v[36:37], v226 offset:3072
ds_read_b64_tr_b16 v[38:39], v226 offset:3584
s_waitcnt lgkmcnt(4)
v_mfma_f32_16x16x32_bf16 v[56:59], v[12:15], v[28:31], v[56:59]
v_bitop3_b32 v68, v28, v29, v225 bitop3:0x7e
v_bitop3_b32 v71, v30, v31, v225 bitop3:0x7e
v_or3_b32 v69, v68, v71, v69
s_waitcnt lgkmcnt(2)
v_mfma_f32_16x16x32_bf16 v[56:59], v[16:19], v[32:35], v[56:59]
v_bitop3_b32 v68, v32, v33, v225 bitop3:0x7e
v_bitop3_b32 v71, v34, v35, v225 bitop3:0x7e
v_or3_b32 v69, v68, v71, v69
s_waitcnt lgkmcnt(0)
v_mfma_f32_16x16x32_bf16 v[56:59], v[20:23], v[36:39], v[56:59]
v_bitop3_b32 v68, v36, v37, v225 bitop3:0x7e
v_bitop3_b32 v71, v38, v39, v225 bitop3:0x7e
v_or3_b32 v69, v68, v71, v69
v_cmp_ne_u32 vcc, 0, v69
s_and_b64 vcc, vcc, s[88:89]
s_cbranch_scc1 L_hretry0
L_hok0:
s_nop 1
v_cvt_pk_f16_f32 v56, v56, v57
v_cvt_pk_f16_f32 v57, v58, v59
L_hchk1:
s_waitcnt vmcnt(3)
ds_read_b64_tr_b16 v[24:25], v226 offset:4096
ds_read_b64_tr_b16 v[26:27], v226 offset:4608
s_waitcnt vmcnt(2)
ds_read_b64_tr_b16 v[28:29], v226 offset:5120
ds_read_b64_tr_b16 v[30:31], v226 offset:5632
s_waitcnt vmcnt(1)
ds_read_b64_tr_b16 v[32:33], v226 offset:6144
ds_read_b64_tr_b16 v[34:35], v226 offset:6656
s_waitcnt lgkmcnt(4)
v_mfma_f32_16x16x32_bf16 v[60:63], v[8:11], v[24:27], 0
v_bitop3_b32 v68, v24, v25, v225 bitop3:0x7e
v_bitop3_b32 v71, v26, v27, v225 bitop3:0x7e
v_or_b32 v69, v68, v71
s_waitcnt lgkmcnt(2)
v_mfma_f32_16x16x32_bf16 v[60:63], v[12:15], v[28:31], v[60:63]
v_bitop3_b32 v68, v28, v29, v225 bitop3:0x7e
v_bitop3_b32 v71, v30, v31, v225 bitop3:0x7e
v_or3_b32 v69, v68, v71, v69
s_waitcnt vmcnt(0)
ds_read_b64_tr_b16 v[36:37], v226 offset:7168
ds_read_b64_tr_b16 v[38:39], v226 offset:7680
s_waitcnt lgkmcnt(2)
v_mfma_f32_16x16x32_bf16 v[60:63], v[16:19], v[32:35], v[60:63]
v_bitop3_b32 v68, v32, v33, v225 bitop3:0x7e
v_bitop3_b32 v71, v34, v35, v225 bitop3:0x7e
v_or3_b32 v69, v68, v71, v69
s_not_b64 exec, s[88:89]
ds_write2st64_b32 v227, v56, v57 offset0:0 offset1:4
ds_write2st64_b32 v228, v56, v57 offset0:32 offset1:36
s_mov_b64 exec, -1
ds_write_b32 v232, v84 offset:28960
s_waitcnt lgkmcnt(3)
v_mfma_f32_16x16x32_bf16 v[60:63], v[20:23], v[36:39], v[60:63]
v_bitop3_b32 v68, v36, v37, v225 bitop3:0x7e
v_bitop3_b32 v71, v38, v39, v225 bitop3:0x7e
v_or3_b32 v69, v68, v71, v69
v_cmp_ne_u32 vcc, 0, v69
s_nop 3
v_cvt_pk_f16_f32 v60, v60, v61
v_cvt_pk_f16_f32 v61, v62, v63
s_not_b64 exec, s[88:89]
ds_write2st64_b32 v228, v60, v61 offset0:0 offset1:4
ds_write2st64_b32 v227, v60, v61 offset0:32 offset1:36
s_mov_b64 exec, -1
s_and_b64 vcc, vcc, s[88:89]
s_cbranch_scc1 L_hretry1
L_hok1:
s_waitcnt lgkmcnt(0)
s_barrier
ds_read_b32 v67, v4 offset:28960
ds_read_b128 v[144:147], v229
ds_read_b128 v[148:151], v230
v_pk_mul_f32 v[112:113], v[112:113], v[128:129]
v_pk_mul_f32 v[114:115], v[114:115], v[130:131]
v_pk_mul_f32 v[116:117], v[116:117], v[132:133]
v_pk_mul_f32 v[118:119], v[118:119], v[134:135]
v_pk_mul_f32 v[120:121], v[120:121], v[136:137]
v_pk_mul_f32 v[122:123], v[122:123], v[138:139]
v_pk_mul_f32 v[124:125], v[124:125], v[140:141]
v_pk_mul_f32 v[126:127], v[126:127], v[142:143]
s_waitcnt lgkmcnt(2)
v_cmp_ne_u32 vcc, v67, v216
v_cmp_ne_u32 s[48:49], v67, v217
s_waitcnt lgkmcnt(1)
v_fma_mix_f32 v96, v144, v112, v96 op_sel:[0,0,0] op_sel_hi:[1,0,0]
v_fma_mix_f32 v97, v145, v113, v97 op_sel:[0,0,0] op_sel_hi:[1,0,0]
v_fma_mix_f32 v98, v146, v114, v98 op_sel:[0,0,0] op_sel_hi:[1,0,0]
v_fma_mix_f32 v99, v147, v115, v99 op_sel:[0,0,0] op_sel_hi:[1,0,0]
v_cndmask_b32_e64 v223, v233, v223, vcc
s_waitcnt lgkmcnt(0)
v_fma_mix_f32 v100, v148, v116, v100 op_sel:[0,0,0] op_sel_hi:[1,0,0]
v_fma_mix_f32 v101, v149, v117, v101 op_sel:[0,0,0] op_sel_hi:[1,0,0]
v_fma_mix_f32 v102, v150, v118, v102 op_sel:[0,0,0] op_sel_hi:[1,0,0]
v_fma_mix_f32 v103, v151, v119, v103 op_sel:[0,0,0] op_sel_hi:[1,0,0]
v_cvt_pk_bf16_f32 v76, v96, v97
v_cvt_pk_bf16_f32 v77, v98, v99
v_cvt_pk_bf16_f32 v78, v100, v101
v_cvt_pk_bf16_f32 v79, v102, v103
buffer_store_dwordx4 v[76:79], v223, s[16:19], 0 offen sc1
v_fma_mix_f32 v104, v144, v120, v104 op_sel:[1,0,0] op_sel_hi:[1,0,0]
v_fma_mix_f32 v105, v145, v121, v105 op_sel:[1,0,0] op_sel_hi:[1,0,0]
v_fma_mix_f32 v106, v146, v122, v106 op_sel:[1,0,0] op_sel_hi:[1,0,0]
v_fma_mix_f32 v107, v147, v123, v107 op_sel:[1,0,0] op_sel_hi:[1,0,0]
v_fma_mix_f32 v108, v148, v124, v108 op_sel:[1,0,0] op_sel_hi:[1,0,0]
v_fma_mix_f32 v109, v149, v125, v109 op_sel:[1,0,0] op_sel_hi:[1,0,0]
v_fma_mix_f32 v110, v150, v126, v110 op_sel:[1,0,0] op_sel_hi:[1,0,0]
v_fma_mix_f32 v111, v151, v127, v111 op_sel:[1,0,0] op_sel_hi:[1,0,0]
v_cndmask_b32 v224, v233, v224, s[48:49]
v_cvt_pk_bf16_f32 v80, v104, v105
v_cvt_pk_bf16_f32 v81, v106, v107
v_cvt_pk_bf16_f32 v82, v108, v109
v_cvt_pk_bf16_f32 v83, v110, v111
buffer_store_dwordx4 v[80:83], v224, s[16:19], 0 offen sc1
L_fin:
s_endpgm
L_hretry0:
s_add_u32 s33, s33, 1
s_cmp_gt_u32 s33, 524288
s_cbranch_scc1 L_hok0
s_mov_b32 m0, s86
s_nop 0
buffer_load_dwordx4 v231, s[20:23], s84 offen offset:0 sc1 lds
buffer_load_dwordx4 v231, s[20:23], s84 offen offset:1024 sc1 lds
buffer_load_dwordx4 v231, s[20:23], s84 offen offset:2048 sc1 lds
buffer_load_dwordx4 v231, s[20:23], s84 offen offset:3072 sc1 lds
s_waitcnt vmcnt(0)
s_branch L_hchk0
L_hretry1:
s_add_u32 s33, s33, 1
s_cmp_gt_u32 s33, 524288
s_cbranch_scc1 L_hok1
s_mov_b32 m0, s87
s_nop 0
buffer_load_dwordx4 v231, s[20:23], s85 offen offset:0 sc1 lds
buffer_load_dwordx4 v231, s[20:23], s85 offen offset:1024 sc1 lds
buffer_load_dwordx4 v231, s[20:23], s85 offen offset:2048 sc1 lds
buffer_load_dwordx4 v231, s[20:23], s85 offen offset:3072 sc1 lds
s_waitcnt vmcnt(0)
s_branch L_hchk1
L_other:
s_cmp_lt_u32 s2, 184
s_cbranch_scc1 L_ffn
s_cmp_ge_u32 s2, 256
s_cbranch_scc1 L_end
s_lshr_b32 s39, s2, 3
s_mul_i32 s40, s24, 9
s_add_u32 s39, s39, s40
s_sub_u32 s39, s39, 23
s_cmp_ge_u32 s24, 4
s_cselect_b32 s40, 32, 0
s_add_u32 s39, s39, s40
s_cmp_ge_u32 s39, 81
s_cbranch_scc1 L_end
s_waitcnt lgkmcnt(0)
s_cmp_ge_u32 s39, 49
s_cbranch_scc1 L_pdh
s_add_u32 s39, s39, 7
s_mul_i32 s42, s39, 9363
s_lshr_b32 s42, s42, 16
s_mul_i32 s44, s42, 7
s_sub_u32 s39, s39, s44
s_lshr_b32 s43, s42, 1
s_lshl2_add_u32 s39, s39, s43
s_mul_i32 s39, s39, 16*3584
s_mul_i32 s43, s25, 448
s_andn2_b32 s43, s43, 127
s_add_u32 s43, s43, s39
v_lshrrev_b32 v11, 2, v0
v_mul_u32_u24 v11, 28, v11
v_and_or_b32 v11, v0, 3, v11
s_bitcmp1_b32 s42, 0
s_cselect_b32 s40, s12, s10
s_cselect_b32 s41, s13, s11
s_branch L_peh
L_pdh:
s_sub_u32 s39, s39, 49
s_cmp_lt_u32 s39, 32
s_cselect_b32 s42, 48, 0
s_cselect_b32 s39, s39, 0
s_lshl_b32 s43, s25, 5
s_add_u32 s43, s43, s39
s_mul_i32 s43, s43, 49*128
v_min_u32 v11, s42, v0
s_mov_b32 s40, s14
s_mov_b32 s41, s15
L_peh:
v_lshl_add_u32 v11, v11, 7, s43
s_mov_b32 s45, 0
L_h1:
s_cmp_lg_u32 s24, s45
s_cbranch_scc1 L_h2
global_load_dword v8, v11, s[40:41]
L_h2:
s_barrier
s_add_u32 s45, s45, 1
s_cmp_lt_u32 s45, 6
s_cbranch_scc1 L_h1
s_endpgm
L_ffn:
s_bfe_u32 s26, s2, 0x30003
s_mul_i32 s29, s25, 7
s_add_u32 s29, s29, s26
v_and_b32 v1, 15, v0
v_lshrrev_b32 v2, 4, v0
v_lshrrev_b32 v3, 3, v0
v_and_b32 v4, 7, v0
s_cmp_eq_u32 s24, 7
s_cbranch_scc1 L_fpoll
v_lshrrev_b32 v5, 2, v0
v_and_b32 v8, 3, v0
v_mul_u32_u24 v10, 3584, v5
v_lshl_add_u32 v10, v8, 4, v10
s_mul_i32 s28, s24, 64*3584
s_lshl_b32 s35, s29, 6
s_add_u32 s28, s28, s35
v_add_u32 v10, s28, v10
v_mul_u32_u24 v14, 896, v3
v_lshl_add_u32 v14, v4, 4, v14
s_mul_i32 s28, s29, 32*896
s_lshl_b32 s36, s24, 7
s_add_u32 s28, s28, s36
v_add_u32 v14, s28, v14
s_lshl_b32 s34, s24, 13
s_add_u32 s34, s34, 4096
s_lshl_b32 s37, s24, 12
s_add_u32 s37, s37, 61440
s_waitcnt lgkmcnt(0)
s_load_dwordx2 s[30:31], s[20:21], 0
s_add_u32 m0, s34, 0
s_nop 0
global_load_lds_dwordx4 v10, s[10:11]
s_lshl_b32 s27, s24, 3
v_add_u32 v7, s27, v3
v_mul_u32_u24 v7, 7168, v7
v_lshl_add_u32 v7, v4, 4, v7
s_lshl_b32 s40, s29, 7
s_add_u32 s40, s40, 196608
s_waitcnt lgkmcnt(0)
v_mov_b32 v102, s30
v_mov_b32 v103, s31
buffer_store_dwordx4 v[100:103], v7, s[20:23], s40 offen sc1
s_add_u32 m0, s34, 1024
s_nop 0
global_load_lds_dwordx4 v10, s[12:13]
v_add_u32 v10, 16*3584, v10
s_waitcnt vmcnt(1)
s_add_u32 m0, s34, 2048
s_nop 0
global_load_lds_dwordx4 v10, s[10:11]
s_waitcnt vmcnt(1)
s_add_u32 m0, s34, 3072
s_nop 0
global_load_lds_dwordx4 v10, s[12:13]
v_add_u32 v10, 16*3584, v10
s_waitcnt vmcnt(1)
s_add_u32 m0, s34, 4096
s_nop 0
global_load_lds_dwordx4 v10, s[10:11]
s_waitcnt vmcnt(1)
s_add_u32 m0, s34, 5120
s_nop 0
global_load_lds_dwordx4 v10, s[12:13]
v_add_u32 v10, 16*3584, v10
s_waitcnt vmcnt(3)
s_add_u32 m0, s34, 6144
s_nop 0
global_load_lds_dwordx4 v10, s[10:11]
s_waitcnt vmcnt(3)
s_add_u32 m0, s34, 7168
s_nop 0
global_load_lds_dwordx4 v10, s[12:13]
s_waitcnt vmcnt(3)
s_add_u32 m0, s37, 0
s_nop 0
global_load_lds_dwordx4 v14, s[14:15]
v_add_u32 v14, 8*896, v14
s_waitcnt vmcnt(3)
s_add_u32 m0, s37, 1024
s_nop 0
global_load_lds_dwordx4 v14, s[14:15]
v_add_u32 v14, 8*896, v14
s_waitcnt vmcnt(3)
s_add_u32 m0, s37, 2048
s_nop 0
global_load_lds_dwordx4 v14, s[14:15]
v_add_u32 v14, 8*896, v14
s_waitcnt vmcnt(3)
s_add_u32 m0, s37, 3072
s_nop 0
global_load_lds_dwordx4 v14, s[14:15]
v_lshl_add_u32 v9, v5, 3, s36
v_lshrrev_b32 v6, 2, v1
v_lshlrev_b32 v11, 3, v8
v_lshl_add_u32 v12, v6, 6, v11
v_lshrrev_b32 v13, 1, v2
v_lshl_add_u32 v12, v13, 10, v12
v_and_b32 v13, 1, v2
v_lshl_add_u32 v12, v13, 5, v12
v_add_u32 v12, s34, v12
v_lshl_add_u32 v13, v6, 7, v11
v_lshl_add_u32 v13, v2, 5, v13
v_add_u32 v13, s37, v13
v_lshlrev_b32 v15, 2, v0
s_lshl_b32 s35, s24, 8
v_add_u32 v11, s35, v15
v_mov_b32 v96, 0
v_mov_b32 v108, 0x3f803f80
v_mov_b32 v109, 0x3f803f80
s_waitcnt lgkmcnt(0)
s_add_u32 s30, s30, 2654435769
s_add_u32 s31, s31, 2135587861
s_waitcnt vmcnt(4)
s_barrier
ds_read_b64_tr_b16 v[32:33], v12 offset:0
ds_read_b64_tr_b16 v[34:35], v12 offset:256
ds_read_b64_tr_b16 v[36:37], v12 offset:512
ds_read_b64_tr_b16 v[38:39], v12 offset:768
ds_read_b64_tr_b16 v[40:41], v12 offset:2048
ds_read_b64_tr_b16 v[42:43], v12 offset:2304
ds_read_b64_tr_b16 v[44:45], v12 offset:2560
ds_read_b64_tr_b16 v[46:47], v12 offset:2816
ds_read_b64_tr_b16 v[48:49], v12 offset:4096
ds_read_b64_tr_b16 v[50:51], v12 offset:4352
ds_read_b64_tr_b16 v[52:53], v12 offset:4608
ds_read_b64_tr_b16 v[54:55], v12 offset:4864
ds_read_b64_tr_b16 v[56:57], v12 offset:6144
ds_read_b64_tr_b16 v[58:59], v12 offset:6400
ds_read_b64_tr_b16 v[60:61], v12 offset:6656
ds_read_b64_tr_b16 v[62:63], v12 offset:6912
s_waitcnt vmcnt(0) lgkmcnt(0)
s_nop 0
ds_read_b64_tr_b16 v[16:17], v13 offset:0
ds_read_b64_tr_b16 v[18:19], v13 offset:512
ds_read_b64_tr_b16 v[20:21], v13 offset:1024
ds_read_b64_tr_b16 v[22:23], v13 offset:1536
ds_read_b64_tr_b16 v[24:25], v13 offset:2048
ds_read_b64_tr_b16 v[26:27], v13 offset:2560
ds_read_b64_tr_b16 v[28:29], v13 offset:3072
ds_read_b64_tr_b16 v[30:31], v13 offset:3584
s_mov_b32 exec_lo, 0x11111111
s_mov_b32 exec_hi, 0x11111111
s_waitcnt lgkmcnt(0)
s_barrier
ds_read_b64 v[108:109], v9 offset:2048
s_mov_b64 exec, -1
ds_read_b64 v[100:101], v96 offset:3072
s_waitcnt lgkmcnt(1)
v_mfma_f32_4x4x4_16b_bf16 v[64:67], v[108:109], v[32:33], 0 cbsz:4 abid:0
s_nop 1
v_mfma_f32_4x4x4_16b_bf16 v[64:67], v[108:109], v[34:35], v[64:67] cbsz:4 abid:1
s_nop 1
v_mfma_f32_4x4x4_16b_bf16 v[64:67], v[108:109], v[36:37], v[64:67] cbsz:4 abid:2
s_nop 1
v_mfma_f32_4x4x4_16b_bf16 v[64:67], v[108:109], v[38:39], v[64:67] cbsz:4 abid:3
s_nop 1
v_mfma_f32_4x4x4_16b_bf16 v[64:67], v[108:109], v[40:41], v[64:67] cbsz:4 abid:4
s_nop 1
v_mfma_f32_4x4x4_16b_bf16 v[64:67], v[108:109], v[42:43], v[64:67] cbsz:4 abid:5
s_nop 1
v_mfma_f32_4x4x4_16b_bf16 v[64:67], v[108:109], v[44:45], v[64:67] cbsz:4 abid:6
s_nop 1
v_mfma_f32_4x4x4_16b_bf16 v[64:67], v[108:109], v[46:47], v[64:67] cbsz:4 abid:7
s_nop 1
v_mfma_f32_4x4x4_16b_bf16 v[64:67], v[108:109], v[48:49], v[64:67] cbsz:4 abid:8
s_nop 1
v_mfma_f32_4x4x4_16b_bf16 v[64:67], v[108:109], v[50:51], v[64:67] cbsz:4 abid:9
s_nop 1
v_mfma_f32_4x4x4_16b_bf16 v[64:67], v[108:109], v[52:53], v[64:67] cbsz:4 abid:10
s_nop 1
v_mfma_f32_4x4x4_16b_bf16 v[64:67], v[108:109], v[54:55], v[64:67] cbsz:4 abid:11
s_nop 1
v_mfma_f32_4x4x4_16b_bf16 v[64:67], v[108:109], v[56:57], v[64:67] cbsz:4 abid:12
s_nop 1
v_mfma_f32_4x4x4_16b_bf16 v[64:67], v[108:109], v[58:59], v[64:67] cbsz:4 abid:13
s_nop 1
v_mfma_f32_4x4x4_16b_bf16 v[64:67], v[108:109], v[60:61], v[64:67] cbsz:4 abid:14
s_nop 1
v_mfma_f32_4x4x4_16b_bf16 v[64:67], v[108:109], v[62:63], v[64:67] cbsz:4 abid:15
s_waitcnt lgkmcnt(0)
s_nop 3
v_fma_f32 v68, -v101, v65, v64
ds_write_b32 v11, v68 offset:0
s_waitcnt lgkmcnt(0)
s_barrier
ds_read2st64_b32 v[70:71], v15 offset0:0 offset1:1
ds_read2st64_b32 v[72:73], v15 offset0:2 offset1:3
ds_read2st64_b32 v[74:75], v15 offset0:4 offset1:5
ds_read_b32 v76, v15 offset:1536
v_mov_b32 v106, s30
v_mov_b32 v107, s31
v_mul_f32 v98, 0xbfb8aa3b, v100
v_mul_f32 v99, v100, v100
s_waitcnt lgkmcnt(2)
v_add_f32 v70, v70, v71
v_add_f32 v72, v72, v73
s_waitcnt lgkmcnt(0)
v_add_f32 v74, v74, v75
v_add_f32 v70, v70, v72
v_add_f32 v74, v74, v76
v_add_f32 v66, v70, v74
v_add_f32 v67, v70, v74
s_nop 1
v_permlane32_swap_b32 v66, v67
v_mul_f32 v68, v98, v66
v_exp_f32 v68, v68
v_mul_f32 v67, v66, v67
v_add_f32 v68, 1.0, v68
v_rcp_f32 v68, v68
v_mul_f32 v67, v67, v99
v_mul_f32 v67, v67, v68
s_nop 1
v_mov_b32_dpp v68, v67 quad_perm:[1,1,3,3] row_mask:0xf bank_mask:0xf
v_cvt_pk_bf16_f32 v70, v67, v68
s_nop 1
v_mov_b32_dpp v71, v70 quad_perm:[2,2,2,2] row_mask:0xf bank_mask:0xf
s_nop 1
v_mfma_f32_4x4x4_16b_bf16 v[76:79], v[70:71], v[16:17], 0 cbsz:4 abid:0
s_nop 1
v_mfma_f32_4x4x4_16b_bf16 v[76:79], v[70:71], v[18:19], v[76:79] cbsz:4 abid:1
s_nop 1
v_mfma_f32_4x4x4_16b_bf16 v[76:79], v[70:71], v[20:21], v[76:79] cbsz:4 abid:2
s_nop 1
v_mfma_f32_4x4x4_16b_bf16 v[76:79], v[70:71], v[22:23], v[76:79] cbsz:4 abid:3
s_nop 1
v_mfma_f32_4x4x4_16b_bf16 v[76:79], v[70:71], v[24:25], v[76:79] cbsz:4 abid:4
s_nop 1
v_mfma_f32_4x4x4_16b_bf16 v[76:79], v[70:71], v[26:27], v[76:79] cbsz:4 abid:5
s_nop 1
v_mfma_f32_4x4x4_16b_bf16 v[76:79], v[70:71], v[28:29], v[76:79] cbsz:4 abid:6
s_nop 1
v_mfma_f32_4x4x4_16b_bf16 v[76:79], v[70:71], v[30:31], v[76:79] cbsz:4 abid:7
s_nop 4
v_mov_b32 v104, v76
buffer_store_dwordx4 v[104:107], v7, s[20:23], s40 offen sc1
s_barrier
s_endpgm
L_fpoll:
s_waitcnt lgkmcnt(0)
s_load_dwordx2 s[30:31], s[20:21], 0
v_lshlrev_b32 v5, 7, v0
s_lshl_b32 s36, s25, 13
s_add_u32 s36, s36, 65536
s_lshl_b32 s27, s29, 3
v_add_u32 v6, s27, v4
v_sub_u32 v7, 448, v6
v_min_u32 v7, v7, v6
v_sub_u32 v8, 224, v7
v_cmp_lt_u32 s[42:43], v8, v7
v_min_u32 v7, v7, v8
v_sub_u32 v8, 112, v7
v_cmp_lt_u32 vcc, v8, v7
v_min_u32 v7, v7, v8
v_mul_u32_u24 v8, 4682, v7
v_lshrrev_b32 v8, 16, v8
v_min_u32 v8, 3, v8
v_mul_u32_u24 v9, 14, v8
v_sub_u32 v9, v7, v9
v_addc_co_u32 v8, vcc, v8, v8, vcc
v_cmp_eq_u32 vcc, 6, v8
v_mov_b32 v7, 0xffff0000
v_cndmask_b32 v47, 0, 8, s[42:43]
v_cndmask_b32 v38, -1, v7, vcc
v_add_lshl_u32 v47, v47, v8, 12
v_lshl_add_u32 v47, v3, 6, v47
v_and_b32 v7, 1, v9
v_mul_u32_u24 v39, 0x020202, v7
v_lshl_add_u32 v39, v7, 25, v39
v_add_u32 v39, 0x05040100, v39
v_and_b32 v7, 12, v9
v_and_b32 v9, 2, v9
v_lshl_add_u32 v9, v7, 1, v9
v_lshl_add_u32 v9, v9, 1, v47
v_lshlrev_b32 v46, 4, v0
s_mov_b32 m0, 2048
s_mul_i32 s41, s29, 7168
s_add_u32 s41, s41, 196608
s_add_u32 s40, s41, 4096
v_cvt_f32_u32 v13, v3
v_mov_b32 v42, 0
s_mov_b32 s33, 0
s_waitcnt lgkmcnt(0)
s_add_u32 s30, s30, 2654435769
s_add_u32 s31, s31, 2135587861
v_mov_b32 v40, s30
v_mov_b32 v41, s31
s_setprio 3
s_barrier
L_kpoll:
buffer_load_dwordx4 v[16:19], v5, s[20:23], s36 offen sc1
s_add_u32 s33, s33, 1
s_cmp_gt_u32 s33, 524288
s_cbranch_scc1 L_kpollx
s_waitcnt vmcnt(0)
v_cmp_ne_u64 vcc, s[30:31], v[18:19]
s_and_b64 exec, exec, vcc
s_cbranch_scc1 L_kpoll
L_kpollx:
s_mov_b64 exec, -1
v_max_u32_dpp v33, v17, v17 quad_perm:[1,0,3,2] row_mask:0xf bank_mask:0xf
s_nop 1
v_max_u32_dpp v33, v33, v33 quad_perm:[2,3,0,1] row_mask:0xf bank_mask:0xf
s_nop 1
v_max_u32_dpp v33, v33, v33 row_half_mirror row_mask:0xf bank_mask:0xf
s_nop 1
v_max_u32_dpp v33, v33, v33 row_mirror row_mask:0xf bank_mask:0xf
s_nop 0
v_readlane_b32 s46, v33, 0
v_readlane_b32 s47, v33, 16
v_readlane_b32 s48, v33, 32
v_readlane_b32 s49, v33, 48
s_max_u32 s46, s46, s47
s_max_u32 s48, s48, s49
s_max_u32 s46, s46, s48
s_and_b32 s48, s46, 0x7ff
s_mul_i32 s49, s48, 896
buffer_load_dwordx4 v46, s[4:7], s49 offen lds
v_cmp_eq_u32 vcc, s46, v17
s_ff1_i32_b64 s47, vcc
v_readlane_b32 s47, v16, s47
s_and_b32 s50, s47, 0xffff0000
s_lshl_b32 s51, s47, 16
v_rcp_f32 v36, s50
v_lshl_add_u32 v10, v6, 1, s49
v_mov_b32 v37, s51
ds_write_b64 v42, v[36:37] offset:3072
s_sub_u32 s52, 0x800, s48
s_and_b32 s52, s52, 0x7ff
s_cmp_lt_u32 s29, 28
s_cselect_b32 s52, s48, s52
s_lshr_b32 s53, s52, 4
s_and_b32 s52, s52, 15
s_lshl_b32 s52, s52, 16
s_add_u32 s52, s52, 1048576
v_cvt_f32_u32 v12, s53
v_mul_f32 v12, 0x3c000000, v12
v_mul_f32 v13, v13, v12
v_mul_f32 v12, 0x41000000, v12
s_bitcmp1_b32 s53, 0
s_cselect_b32 s53, -1.0, 1.0
v_mov_b32 v14, s53
v_cmp_eq_u32 vcc, 0, v3
s_waitcnt vmcnt(0) lgkmcnt(0)
s_barrier
s_setprio 0
v_lshlrev_b32 v11, 1, v6
ds_read_u16 v11, v11 offset:2048
s_andn2_b32 s46, s46, 0x7ff
s_ashr_i32 s47, s46, 31
s_not_b32 s47, s47
s_or_b32 s47, s47, 0x80000000
s_xor_b32 s46, s46, s47
v_mov_b32 v15, s46
v_mul_f32 v15, 0xbfb8aa3b, v15
v_exp_f32 v15, v15
s_nop 0
v_add_f32 v15, 1.0, v15
v_rcp_f32 v15, v15
s_mov_b32 s33, 0
s_waitcnt lgkmcnt(0)
s_mov_b64 exec, 0xff
buffer_store_short v11, v10, s[16:19], 0 offen sc1
s_mov_b64 exec, -1
v_lshlrev_b32 v11, 16, v11
v_sub_f32 v45, v11, v37
v_mul_f32 v45, v45, v36
s_cmp_lg_u32 s29, 0
s_cbranch_scc1 L_noa0
v_lshlrev_b32_e64 v34, 6, v0
s_add_u32 s35, s52, 16384
buffer_load_dwordx3 v[28:30], v34, s[20:23], s35 offen offset:52 sc1
L_noa0:
buffer_load_dwordx3 v[64:66], v47, s[20:23], s52 offen offset:52 sc1
buffer_load_dwordx3 v[68:70], v47, s[20:23], s52 offen offset:564 sc1
buffer_load_dwordx3 v[72:74], v47, s[20:23], s52 offen offset:1076 sc1
buffer_load_dwordx3 v[76:78], v47, s[20:23], s52 offen offset:1588 sc1
buffer_load_dwordx3 v[80:82], v47, s[20:23], s52 offen offset:2100 sc1
buffer_load_dwordx3 v[84:86], v47, s[20:23], s52 offen offset:2612 sc1
buffer_load_dwordx3 v[88:90], v47, s[20:23], s52 offen offset:3124 sc1
buffer_load_dwordx3 v[92:94], v47, s[20:23], s52 offen offset:3636 sc1
buffer_load_dwordx3 v[96:98], v9, s[20:23], s52 offen offset:0 sc1
buffer_load_dwordx3 v[100:102], v9, s[20:23], s52 offen offset:512 sc1
buffer_load_dwordx3 v[104:106], v9, s[20:23], s52 offen offset:1024 sc1
buffer_load_dwordx3 v[108:110], v9, s[20:23], s52 offen offset:1536 sc1
buffer_load_dwordx3 v[112:114], v9, s[20:23], s52 offen offset:2048 sc1
buffer_load_dwordx3 v[116:118], v9, s[20:23], s52 offen offset:2560 sc1
buffer_load_dwordx3 v[120:122], v9, s[20:23], s52 offen offset:3072 sc1
buffer_load_dwordx3 v[124:126], v9, s[20:23], s52 offen offset:3584 sc1
s_barrier
v_cos_f32 v16, v13
v_sin_f32 v17, v13
v_add_f32 v13, v13, v12
v_cndmask_b32 v17, v17, v14, vcc
v_cvt_pk_bf16_f32 v48, v16, v17
v_cos_f32 v16, v13
v_sin_f32 v17, v13
v_add_f32 v13, v13, v12
v_cvt_pk_bf16_f32 v49, v16, v17
v_cos_f32 v16, v13
v_sin_f32 v17, v13
v_add_f32 v13, v13, v12
v_cvt_pk_bf16_f32 v50, v16, v17
v_cos_f32 v16, v13
v_sin_f32 v17, v13
v_add_f32 v13, v13, v12
v_cvt_pk_bf16_f32 v51, v16, v17
v_cos_f32 v16, v13
v_sin_f32 v17, v13
v_add_f32 v13, v13, v12
v_cvt_pk_bf16_f32 v52, v16, v17
v_cos_f32 v16, v13
v_sin_f32 v17, v13
v_add_f32 v13, v13, v12
v_cvt_pk_bf16_f32 v53, v16, v17
v_cos_f32 v16, v13
v_sin_f32 v17, v13
v_add_f32 v13, v13, v12
v_cvt_pk_bf16_f32 v54, v16, v17
v_cos_f32 v16, v13
v_sin_f32_e64 v17, v13
s_nop 0
v_cvt_pk_bf16_f32 v55, v16, v17
s_waitcnt vmcnt(8)
L_hpoll:
v_bitop3_b32 v20, v64, v68, v40 bitop3:0x7e
v_bitop3_b32 v21, v66, v70, v41 bitop3:0x7e
v_bitop3_b32 v22, v72, v76, v40 bitop3:0x7e
v_bitop3_b32 v23, v74, v78, v41 bitop3:0x7e
v_bitop3_b32 v24, v80, v84, v40 bitop3:0x7e
v_bitop3_b32 v25, v82, v86, v41 bitop3:0x7e
v_bitop3_b32 v26, v88, v92, v40 bitop3:0x7e
v_bitop3_b32 v27, v90, v94, v41 bitop3:0x7e
v_or3_b32 v20, v20, v22, v24
v_or3_b32 v21, v21, v23, v25
v_or3_b32 v20, v20, v26, v27
v_or_b32 v20, v20, v21
v_and_b32 v20, v20, v38
v_cmp_ne_u32 vcc, 0, v20
s_cbranch_vccz L_hpollx
s_add_u32 s33, s33, 1
s_cmp_gt_u32 s33, 524288
s_cbranch_scc1 L_hpollx
buffer_load_dwordx3 v[64:66], v47, s[20:23], s52 offen offset:52 sc1
buffer_load_dwordx3 v[68:70], v47, s[20:23], s52 offen offset:564 sc1
buffer_load_dwordx3 v[72:74], v47, s[20:23], s52 offen offset:1076 sc1
buffer_load_dwordx3 v[76:78], v47, s[20:23], s52 offen offset:1588 sc1
buffer_load_dwordx3 v[80:82], v47, s[20:23], s52 offen offset:2100 sc1
buffer_load_dwordx3 v[84:86], v47, s[20:23], s52 offen offset:2612 sc1
buffer_load_dwordx3 v[88:90], v47, s[20:23], s52 offen offset:3124 sc1
buffer_load_dwordx3 v[92:94], v47, s[20:23], s52 offen offset:3636 sc1
buffer_load_dwordx3 v[96:98], v9, s[20:23], s52 offen offset:0 sc1
buffer_load_dwordx3 v[100:102], v9, s[20:23], s52 offen offset:512 sc1
buffer_load_dwordx3 v[104:106], v9, s[20:23], s52 offen offset:1024 sc1
buffer_load_dwordx3 v[108:110], v9, s[20:23], s52 offen offset:1536 sc1
buffer_load_dwordx3 v[112:114], v9, s[20:23], s52 offen offset:2048 sc1
buffer_load_dwordx3 v[116:118], v9, s[20:23], s52 offen offset:2560 sc1
buffer_load_dwordx3 v[120:122], v9, s[20:23], s52 offen offset:3072 sc1
buffer_load_dwordx3 v[124:126], v9, s[20:23], s52 offen offset:3584 sc1
s_waitcnt vmcnt(0)
s_branch L_hpoll
L_hpollx:
v_mov_b32 v44, 0
s_waitcnt vmcnt(0)
v_perm_b32 v56, v98, v96, v39
v_perm_b32 v57, v102, v100, v39
v_perm_b32 v58, v106, v104, v39
v_perm_b32 v59, v110, v108, v39
v_perm_b32 v60, v114, v112, v39
v_perm_b32 v61, v118, v116, v39
v_perm_b32 v62, v122, v120, v39
v_perm_b32 v63, v126, v124, v39
v_dot2c_f32_bf16 v44, v48, v56
v_dot2c_f32_bf16 v44, v49, v57
v_dot2c_f32_bf16 v44, v50, v58
v_dot2c_f32_bf16 v44, v51, v59
v_dot2c_f32_bf16 v44, v52, v60
v_dot2c_f32_bf16 v44, v53, v61
v_dot2c_f32_bf16 v44, v54, v62
v_dot2c_f32_bf16 v44, v55, v63
s_nop 2
v_add_f32_dpp v44, v44, v44 row_ror:8 row_mask:0xf bank_mask:0xf
v_mov_b32 v43, v44
s_nop 1
v_permlane16_swap_b32 v44, v43
v_add_f32 v16, v44, v43
v_add_f32 v17, v44, v43
s_nop 1
v_permlane32_swap_b32 v16, v17
v_add_f32_e64 v44, v16, v17
s_mov_b32 s33, 0
s_barrier
L_ppoll:
buffer_load_dwordx4 v[128:131], v46, s[20:23], s41 offen offset:0 sc1
buffer_load_dwordx4 v[132:135], v46, s[20:23], s41 offen offset:1024 sc1
buffer_load_dwordx4 v[136:139], v46, s[20:23], s41 offen offset:2048 sc1
buffer_load_dwordx4 v[140:143], v46, s[20:23], s41 offen offset:3072 sc1
buffer_load_dwordx4 v[144:147], v46, s[20:23], s40 offen offset:0 sc1
buffer_load_dwordx4 v[148:151], v46, s[20:23], s40 offen offset:1024 sc1
buffer_load_dwordx4 v[152:155], v46, s[20:23], s40 offen offset:2048 sc1
L_pe1:
s_add_u32 s33, s33, 1
s_cmp_gt_u32 s33, 524288
s_cbranch_scc1 L_ppollx
s_waitcnt vmcnt(5)
v_bitop3_b32 v20, v130, v134, v40 bitop3:0x7e
v_bitop3_b32 v21, v131, v135, v41 bitop3:0x7e
v_add_f32 v16, v128, v132
s_waitcnt vmcnt(3)
v_bitop3_b32 v22, v138, v142, v40 bitop3:0x7e
v_bitop3_b32 v23, v139, v143, v41 bitop3:0x7e
v_add_f32 v17, v136, v140
v_or3_b32 v20, v20, v21, v22
s_waitcnt vmcnt(1)
v_bitop3_b32 v21, v146, v150, v40 bitop3:0x7e
v_bitop3_b32 v22, v147, v151, v41 bitop3:0x7e
v_add_f32 v18, v144, v148
v_add_f32 v16, v16, v17
v_or3_b32 v20, v20, v21, v22
v_add_f32 v16, v16, v18
v_or_b32 v20, v20, v23
s_waitcnt vmcnt(0)
v_add_f32 v16, v16, v152
v_cmp_ne_u32 s[42:43], 0, v20
v_cmp_ne_u64 vcc, s[30:31], v[154:155]
v_add_f32_dpp v16, v16, v16 row_ror:8 row_mask:0xf bank_mask:0xf
v_mov_b32 v17, v16
s_or_b64 vcc, vcc, s[42:43]
s_cbranch_scc1 L_ppoll
L_ppollx:
v_permlane16_swap_b32 v16, v17
v_add_f32 v18, v16, v17
v_add_f32 v19, v16, v17
s_nop 1
v_permlane32_swap_b32 v18, v19
v_add_f32 v16, v18, v19
v_fmac_f32 v45, v16, v15
v_mul_f32 v16, 0xbfb8aa3b, v45
v_exp_f32 v16, v16
v_mul_f32 v45, v45, v44
v_add_f32 v16, 1.0, v16
v_rcp_f32 v16, v16
s_mov_b64 exec, 0xff
v_fmac_f32 v11, v45, v16
v_cvt_pk_bf16_f32 v11, v11, v11
buffer_store_short v11, v10, s[16:19], 0 offen sc1
s_cmp_lg_u32 s29, 0
s_cbranch_scc1 L_noctl
s_mov_b64 exec, -1
s_mov_b32 s34, 0
v_lshlrev_b32 v34, 6, v0
L_apoll:
v_mov_b32 v29, v30
v_cmp_ne_u64 vcc, s[30:31], v[28:29]
s_cbranch_vccz L_aok
buffer_load_dwordx3 v[28:30], v34, s[20:23], s35 offen offset:52 sc1
s_add_u32 s34, s34, 1
s_cmp_lt_u32 s34, 524288
s_waitcnt vmcnt(0)
s_cbranch_scc1 L_apoll
L_aok:
s_mov_b64 exec, 1
buffer_store_dwordx2 v[40:41], off, s[20:23], 0 sc1
L_noctl:
L_end:
s_endpgm
.fill 1024, 4, 0xbf810000
.section .rodata,"a"
.p2align 6
.amdhsa_kernel recurrent_scan__spectral_fnet__moe_arch_mod__prompt_kernel
.amdhsa_next_free_vgpr 256
.amdhsa_next_free_sgpr 100
.amdhsa_accum_offset 256
.amdhsa_group_segment_fixed_size 0
.amdhsa_kernarg_size 104
.amdhsa_user_sgpr_count 2
.amdhsa_user_sgpr_kernarg_segment_ptr 1
.amdhsa_system_sgpr_workgroup_id_x 1
.end_amdhsa_kernel
```
